```python
import torch

def _softmax(x, axis=-1):
    return torch.softmax(x, dim=axis)
def _gelu(x):
    return torch.nn.functional.gelu(x, approximate="tanh")
def _silu(x):
    return torch.nn.functional.silu(x)
def _sigmoid(x):
    return torch.sigmoid(x)
def _layernorm(x, axis=-1, eps=1e-5):
    m = x.mean(dim=axis, keepdim=True)
    v = x.var(dim=axis, keepdim=True, unbiased=False)
    return (x - m) / torch.sqrt(v + eps)
def _scatter_add(tgt, idx, src, axis=0):
    return tgt.clone().index_add_(axis, idx, src)
def _segment_sum(src, seg, n):
    out = torch.zeros((n,) + src.shape[1:], dtype=src.dtype)
    return out.index_add_(0, seg, src)
def _pad(x, pw):
    flat = tuple(v for pair in reversed(pw) for v in pair)
    return torch.nn.functional.pad(x, flat)

kernel_name = 'concat_heads__gqa_block_cached__gqa_block_cached__near_ridge'

def setup_inputs():

    _w = (lambda a: (lambda t: t.to(torch.bfloat16) if t.is_floating_point() else t)(torch.as_tensor(a)))
    def _A_setup():
        B, Sq, D = 16, 32, 1024
        Hq, Hkv, Sk, Dh = 32, 4, 32, 128
        assert Hq % Hkv == 0, (Hq, Hkv)
        return {
            "x": _w((lambda *s: torch.randn(*s, dtype=torch.bfloat16) * 0.8)(B, Sq, D)),
            "k_cache": _w((lambda *s: torch.randn(*s, dtype=torch.bfloat16) * 0.8)(B, Hkv, Sk, Dh)),
            "v_cache": _w((lambda *s: torch.randn(*s, dtype=torch.bfloat16) * 0.05)(B, Hkv, Sk, Dh)),
            "wq": _w((lambda *s: torch.randn(*s, dtype=torch.bfloat16) * 0.8)(D, Hq * Dh) * (D ** -0.5)),
            "wo": _w((lambda *s: torch.randn(*s, dtype=torch.bfloat16) * 0.05)(Hq * Dh, D) * ((Hq * Dh) ** -0.5)),
        }
    _A_in = _A_setup()

    def _B_setup():
        B, Sq, D = 16, 32, 1024
        Hq, Hkv, Sk, Dh = 32, 4, 32, 128
        assert Hq % Hkv == 0, (Hq, Hkv)
        return {
            "x": _w((lambda *s: torch.randn(*s, dtype=torch.bfloat16) * 0.8)(B, Sq, D)),
            "k_cache": _w((lambda *s: torch.randn(*s, dtype=torch.bfloat16) * 0.8)(B, Hkv, Sk, Dh)),
            "v_cache": _w((lambda *s: torch.randn(*s, dtype=torch.bfloat16) * 0.05)(B, Hkv, Sk, Dh)),
            "wq": _w((lambda *s: torch.randn(*s, dtype=torch.bfloat16) * 0.8)(D, Hq * Dh) * (D ** -0.5)),
            "wo": _w((lambda *s: torch.randn(*s, dtype=torch.bfloat16) * 0.05)(Hq * Dh, D) * ((Hq * Dh) ** -0.5)),
        }
    _B_in = _B_setup()

    return {
        "A_x": _A_in["x"],
        "A_k_cache": _A_in["k_cache"],
        "A_v_cache": _A_in["v_cache"],
        "A_wq": _A_in["wq"],
        "A_wo": _A_in["wo"],
        "B_x": _B_in["x"],
        "B_k_cache": _B_in["k_cache"],
        "B_v_cache": _B_in["v_cache"],
        "B_wq": _B_in["wq"],
        "B_wo": _B_in["wo"],
    }

def reference(A_x, A_k_cache, A_v_cache, A_wq, A_wo, B_x, B_k_cache, B_v_cache, B_wq, B_wo):
    def _A_ref(x, k_cache, v_cache, wq, wo):
        B, Sq, D = x.shape
        Hq, Dh = 32, 128
        Hkv = k_cache.shape[1]
        rep = Hq // Hkv
        q = (lambda x, *d: x.permute(*d))((x @ wq).reshape(B, Sq, Hq, Dh), 0, 2, 1, 3)
        k = (lambda x, n, axis: torch.repeat_interleave(x, n, dim=axis))(k_cache, rep, axis=1)
        v = (lambda x, n, axis: torch.repeat_interleave(x, n, dim=axis))(v_cache, rep, axis=1)
        scores = torch.einsum("bhqd,bhkd->bhqk", q, k) * (Dh ** -0.5)
        p = _softmax(scores, axis=-1)
        o = torch.einsum("bhqk,bhkd->bhqd", p, v)
        return (lambda x, *d: x.permute(*d))(o, 0, 2, 1, 3).reshape(B, Sq, Hq * Dh) @ wo

    def _B_ref(x, k_cache, v_cache, wq, wo):
        B, Sq, D = x.shape
        Hq, Dh = 32, 128
        Hkv = k_cache.shape[1]
        rep = Hq // Hkv
        q = (lambda x, *d: x.permute(*d))((x @ wq).reshape(B, Sq, Hq, Dh), 0, 2, 1, 3)
        k = (lambda x, n, axis: torch.repeat_interleave(x, n, dim=axis))(k_cache, rep, axis=1)
        v = (lambda x, n, axis: torch.repeat_interleave(x, n, dim=axis))(v_cache, rep, axis=1)
        scores = torch.einsum("bhqd,bhkd->bhqk", q, k) * (Dh ** -0.5)
        p = _softmax(scores, axis=-1)
        o = torch.einsum("bhqk,bhkd->bhqd", p, v)
        return (lambda x, *d: x.permute(*d))(o, 0, 2, 1, 3).reshape(B, Sq, Hq * Dh) @ wo

    a = _A_ref(A_x, A_k_cache, A_v_cache, A_wq, A_wo)
    b = _B_ref(B_x, B_k_cache, B_v_cache, B_wq, B_wo)
    return torch.concatenate([a, b], axis=-1)
```

```asm
; @launch grid=(256,1,1) block=(256,1,1) lds=163840
.amdgcn_target "amdgcn-amd-amdhsa--gfx950"
.text
.globl concat_heads__gqa_block_cached__gqa_block_cached__near_ridge_kernel
.p2align 8
.type concat_heads__gqa_block_cached__gqa_block_cached__near_ridge_kernel,@function
concat_heads__gqa_block_cached__gqa_block_cached__near_ridge_kernel:
    s_cmp_ge_u32 s2, 256
    s_cbranch_scc1 L_end
    s_load_dwordx16 s[36:51], s[0:1], 0
    s_load_dwordx8 s[52:59], s[0:1], 64
    s_load_dwordx2 s[60:61], s[0:1], 96
    s_memrealtime s[98:99]
    v_lshrrev_b32 v29, 6, v0
    v_and_b32 v0, 63, v0
    v_readfirstlane_b32 s68, v29
    s_and_b32 s3, s2, 3
    s_bfe_u32 s4, s2, 0x10002
    s_lshr_b32 s5, s2, 3
    s_and_b32 s6, s5, 7
    s_lshl_b32 s7, s3, 3
    s_add_u32 s6, s6, s7
    s_lshr_b32 s7, s5, 3
    s_mul_i32 s70, s68, 40960
    v_lshrrev_b32 v29, 3, v0
    v_and_b32 v30, 7, v0
    v_lshrrev_b32 v31, 4, v0
    v_xor_b32 v9, v30, v31
    v_xor_b32 v10, 4, v9
    v_lshlrev_b32 v9, 4, v9
    v_lshlrev_b32 v10, 4, v10
    s_lshl_b32 s81, s7, 18
    s_lshl_b32 s82, s68, 9
    s_add_u32 s81, s81, s82
    v_lshl_add_u32 v1, v29, 11, s81
    v_add_u32 v2, v1, v10
    v_add_u32 v1, v1, v9
    v_add_u32 v2, 15360, v2
    v_add_u32 v3, 30720, v1
    v_add_u32 v4, 30720, v2
    v_and_b32 v5, 15, v0
    v_lshlrev_b32 v6, 2, v31
    v_xor_b32 v5, v5, v6
    v_lshlrev_b32 v5, 4, v5
    v_lshl_add_u32 v5, v31, 13, v5
    s_lshl_b32 s81, s68, 21
    s_lshl_b32 s82, s6, 8
    s_add_u32 s81, s81, s82
    v_add_u32 v5, s81, v5
    v_add_u32 v6, 31744, v5
    v_add_u32 v7, 63488, v5
    v_add_u32 v8, 95232, v5
    s_lshl_b32 s71, s7, 17
    s_lshl_b32 s72, s68, 16
    s_xor_b32 s73, s72, 0x10000
    s_xor_b32 s74, s72, 0x20000
    s_xor_b32 s75, s72, 0x30000
    s_mov_b32 s10, 0x100000
    s_mov_b32 s11, 0x20000
    s_mov_b32 s14, 0x800000
    s_mov_b32 s15, 0x20000
    s_cmp_eq_u32 s4, 0
    s_waitcnt lgkmcnt(0)
    s_cselect_b32 s8, s36, s46
    s_cselect_b32 s9, s37, s47
    s_cselect_b32 s12, s42, s52
    s_cselect_b32 s13, s43, s53
    s_add_u32 m0, s70, 0
    s_add_u32 s80, s73, 0
    buffer_load_dwordx4 v1, s[8:11], s80 offen offset:0 lds
    buffer_load_dwordx4 v2, s[8:11], s80 offen offset:1024 lds
    buffer_load_dwordx4 v3, s[8:11], s80 offen offset:2048 lds
    buffer_load_dwordx4 v4, s[8:11], s80 offen offset:3072 lds
    s_add_u32 m0, s70, 4096
    s_add_u32 s80, s71, 0
    buffer_load_dwordx4 v5, s[12:15], s80 offen offset:0 lds
    buffer_load_dwordx4 v6, s[12:15], s80 offen offset:1024 lds
    buffer_load_dwordx4 v7, s[12:15], s80 offen offset:2048 lds
    buffer_load_dwordx4 v8, s[12:15], s80 offen offset:3072 lds
    s_add_u32 m0, s70, 8192
    s_add_u32 s80, s74, 0
    buffer_load_dwordx4 v1, s[8:11], s80 offen offset:0 lds
    buffer_load_dwordx4 v2, s[8:11], s80 offen offset:1024 lds
    buffer_load_dwordx4 v3, s[8:11], s80 offen offset:2048 lds
    buffer_load_dwordx4 v4, s[8:11], s80 offen offset:3072 lds
    s_cmp_eq_u32 s4, 0
    s_cselect_b32 s16, s38, s48
    s_cselect_b32 s17, s39, s49
    s_cselect_b32 s20, s40, s50
    s_cselect_b32 s21, s41, s51
    s_cselect_b32 s24, s44, s54
    s_cselect_b32 s25, s45, s55
    s_mov_b32 s28, s60
    s_mov_b32 s29, s61
    s_mov_b32 s32, s56
    s_mov_b32 s33, s57
    s_mov_b32 s64, s58
    s_mov_b32 s65, s59
    s_mov_b32 s66, 256
    s_mov_b32 s67, 0x20000
    s_or_b32 s81, s2, s68
    s_cbranch_scc1 L_nonon
    s_or_b32 s98, s98, 1
    v_mov_b32 v18, s98
    v_lshlrev_b32 v19, 6, v0
    s_mov_b64 exec, 15
    buffer_store_dword v18, v19, s[64:67], 0 offen sc1
    s_mov_b64 exec, -1
L_nonon:
    s_and_b32 s62, s5, 3
    s_lshl_b32 s63, s3, 2
    s_add_u32 s62, s62, s63
    s_lshr_b32 s63, s5, 2
    s_mov_b32 s18, 0x80000
    s_mov_b32 s19, 0x20000
    s_mov_b32 s22, 0x80000
    s_mov_b32 s23, 0x20000
    s_mov_b32 s26, 0x800000
    s_mov_b32 s27, 0x20000
    s_mov_b32 s30, 0x243000
    s_mov_b32 s31, 0x20000
    s_mov_b32 s34, 0x200000
    s_mov_b32 s35, 0x20000
    v_and_b32 v13, 1, v31
    v_lshlrev_b32 v13, 2, v13
    v_xor_b32 v13, v13, v30
    v_lshlrev_b32 v13, 4, v13
    v_lshl_add_u32 v13, v29, 11, v13
    s_lshl_b32 s81, s68, 21
    s_lshl_b32 s82, s62, 7
    s_add_u32 s81, s81, s82
    v_add_u32 v13, s81, v13
    v_add_u32 v14, 15360, v13
    v_add_u32 v15, 30720, v13
    v_add_u32 v16, 46080, v13
    v_lshl_add_u32 v9, v29, 8, v9
    v_lshl_add_u32 v10, v29, 8, v10
    v_add_u32 v10, 1024, v10
    v_add_u32 v11, 2048, v9
    v_add_u32 v12, 2048, v10
    s_lshl_b32 s76, s7, 2
    s_add_u32 s76, s76, s68
    s_lshl_b32 s76, s76, 15
    s_lshl_b32 s81, s3, 13
    s_add_u32 s76, s76, s81
    s_lshr_b32 s69, s68, 1
    s_lshl_b32 s77, s63, 1
    s_add_u32 s77, s77, s69
    s_lshl_b32 s77, s77, 15
    s_lshl_b32 s81, s68, 13
    s_add_u32 s77, s77, s81
    s_xor_b32 s78, s77, 0x8000
    s_lshl_b32 s81, s4, 3
    s_add_u32 s81, s81, s63
    s_lshl_b32 s81, s81, 17
    s_lshl_b32 s82, s68, 15
    s_add_u32 s81, s81, s82
    s_add_u32 s57, s81, 0x1000
    v_lshl_add_u32 v28, v0, 4, s70
    v_and_b32 v29, 31, v0
    v_lshrrev_b32 v30, 5, v0
    v_bfe_u32 v31, v0, 1, 3
    v_xor_b32 v31, v31, v30
    v_lshl_add_u32 v29, v29, 7, s70
    v_lshl_add_u32 v18, v31, 4, v29
    v_xor_b32 v19, 2, v31
    v_lshl_add_u32 v19, v19, 4, v29
    v_xor_b32 v20, 4, v31
    v_lshl_add_u32 v20, v20, 4, v29
    v_xor_b32 v21, 6, v31
    v_lshl_add_u32 v21, v21, 4, v29
    v_bfe_u32 v29, v0, 2, 2
    v_lshl_add_u32 v30, v30, 3, v29
    v_bfe_u32 v31, v0, 1, 1
    v_lshlrev_b32 v31, 3, v31
    v_add_u32 v31, s70, v31
    v_lshl_add_u32 v26, v30, 7, v31
    v_lshl_add_u32 v31, v30, 8, v31
    v_and_b32 v30, 16, v0
    v_add_u32 v26, v26, v30
    v_lshl_add_u32 v31, v30, 1, v31
    v_and_b32 v30, 1, v0
    v_lshl_add_u32 v26, v30, 5, v26
    v_lshl_add_u32 v31, v30, 4, v31
    v_lshl_add_u32 v22, v29, 6, v31
    v_xor_b32 v23, 1, v29
    v_lshl_add_u32 v23, v23, 6, v31
    v_xor_b32 v24, 2, v29
    v_lshl_add_u32 v24, v24, 6, v31
    v_xor_b32 v25, 3, v29
    v_lshl_add_u32 v25, v25, 6, v31
    v_lshrrev_b32 v29, 1, v29
    s_and_b32 s81, s68, 1
    v_xor_b32 v29, s81, v29
    v_xor_b32 v30, 1, v29
    v_lshl_add_u32 v27, v30, 6, v26
    v_lshl_add_u32 v26, v29, 6, v26
    s_xor_b32 s81, s68, 1
    s_mul_i32 s41, s81, 40960
    s_sub_u32 s41, s41, s70
    s_xor_b32 s81, s68, 2
    s_mul_i32 s42, s81, 40960
    s_sub_u32 s42, s42, s70
    s_xor_b32 s81, s68, 3
    s_mul_i32 s43, s81, 40960
    s_sub_u32 s43, s43, s70
    s_lshl_b32 s81, s4, 2
    s_add_u32 s82, s81, s7
    s_lshl_b32 s82, s82, 2
    s_add_u32 s82, s82, s3
    s_lshl_b32 s82, s82, 6
    s_and_b32 s44, s6, 7
    s_add_u32 s44, s82, s44
    s_lshl_b32 s44, s44, 2
    s_add_u32 s44, s44, 0x240000
    s_lshr_b32 s82, s63, 1
    s_add_u32 s82, s82, s81
    s_lshl_b32 s82, s82, 2
    s_add_u32 s82, s82, s68
    s_lshl_b32 s45, s82, 8
    s_add_u32 s45, s45, 0x240000
    s_lshl_b32 s79, s68, 6
    s_lshl_b32 s81, s4, 3
    s_lshl_b32 s82, s7, 1
    s_add_u32 s81, s81, s82
    s_add_u32 s81, s81, s69
    s_lshl_b32 s81, s81, 5
    s_add_u32 s81, s81, s6
    s_lshl_b32 s81, s81, 12
    s_and_b32 s82, s68, 1
    s_lshl_b32 s82, s82, 11
    s_add_u32 s46, s81, s82
    s_add_u32 s46, s46, 0x1000
    s_lshl_b32 s81, s63, 1
    s_add_u32 s81, s81, s69
    s_lshl_b32 s81, s81, 17
    s_lshl_b32 s82, s4, 11
    s_add_u32 s81, s81, s82
    s_lshl_b32 s82, s62, 7
    s_add_u32 s81, s81, s82
    s_and_b32 s82, s68, 1
    s_lshl_b32 s82, s82, 6
    s_add_u32 s47, s81, s82
    s_mov_b32 s48, 0x3e0293ee
    s_xor_b32 s50, s71, 131072
    s_xor_b32 s51, s71, 262144
    s_xor_b32 s52, s71, 393216
    s_lshl_b32 s40, s7, 5
    v_xor_b32 v18, s40, v18
    v_xor_b32 v19, s40, v19
    v_xor_b32 v20, s40, v20
    v_xor_b32 v21, s40, v21
    s_lshl_b32 s82, s62, 1
    s_add_u32 s82, s82, s63
    s_add_u32 s81, s82, 0
    s_and_b32 s81, s81, 7
    s_lshl_b32 s90, s81, 18
    s_add_u32 s81, s82, 1
    s_and_b32 s81, s81, 7
    s_lshl_b32 s91, s81, 18
    s_add_u32 s81, s82, 2
    s_and_b32 s81, s81, 7
    s_lshl_b32 s92, s81, 18
    s_add_u32 s81, s82, 3
    s_and_b32 s81, s81, 7
    s_lshl_b32 s93, s81, 18
    s_add_u32 s81, s82, 4
    s_and_b32 s81, s81, 7
    s_lshl_b32 s94, s81, 18
    s_add_u32 s81, s82, 5
    s_and_b32 s81, s81, 7
    s_lshl_b32 s95, s81, 18
    s_add_u32 s81, s82, 6
    s_and_b32 s81, s81, 7
    s_lshl_b32 s96, s81, 18
    s_add_u32 s81, s82, 7
    s_and_b32 s81, s81, 7
    s_lshl_b32 s97, s81, 18
    s_add_u32 m0, s70, 12288
    s_add_u32 s80, s50, 0
    buffer_load_dwordx4 v5, s[12:15], s80 offen offset:0 lds
    buffer_load_dwordx4 v6, s[12:15], s80 offen offset:1024 lds
    buffer_load_dwordx4 v7, s[12:15], s80 offen offset:2048 lds
    buffer_load_dwordx4 v8, s[12:15], s80 offen offset:3072 lds
    s_add_u32 m0, s70, 16384
    s_add_u32 s80, s75, 0
    buffer_load_dwordx4 v1, s[8:11], s80 offen offset:0 lds
    buffer_load_dwordx4 v2, s[8:11], s80 offen offset:1024 lds
    buffer_load_dwordx4 v3, s[8:11], s80 offen offset:2048 lds
    buffer_load_dwordx4 v4, s[8:11], s80 offen offset:3072 lds
    s_waitcnt vmcnt(16)
    ds_read_b128 a[16:19], v18 offset:0
    ds_read_b128 a[20:23], v19 offset:0
    ds_read_b128 a[24:27], v20 offset:0
    ds_read_b128 a[28:31], v21 offset:0
    s_waitcnt lgkmcnt(0)
    s_add_u32 m0, s70, 20480
    s_add_u32 s80, s72, 0
    buffer_load_dwordx4 v1, s[8:11], s80 offen offset:0 lds
    buffer_load_dwordx4 v2, s[8:11], s80 offen offset:1024 lds
    buffer_load_dwordx4 v3, s[8:11], s80 offen offset:2048 lds
    buffer_load_dwordx4 v4, s[8:11], s80 offen offset:3072 lds
    s_waitcnt vmcnt(16)
    ds_read_b64_tr_b16 a[128:129], v22 offset:4096
    ds_read_b64_tr_b16 a[130:131], v22 offset:5120
    ds_read_b64_tr_b16 a[132:133], v23 offset:4096
    ds_read_b64_tr_b16 a[134:135], v23 offset:5120
    ds_read_b64_tr_b16 a[136:137], v24 offset:4096
    ds_read_b64_tr_b16 a[138:139], v24 offset:5120
    ds_read_b64_tr_b16 a[140:141], v25 offset:4096
    ds_read_b64_tr_b16 a[142:143], v25 offset:5120
    s_waitcnt lgkmcnt(0)
    v_mfma_f32_32x32x16_bf16 a[160:175], a[128:131], a[16:19], 0
    v_mfma_f32_32x32x16_bf16 a[176:191], a[132:135], a[16:19], 0
    v_mfma_f32_32x32x16_bf16 v[32:47], a[136:139], a[16:19], 0
    v_mfma_f32_32x32x16_bf16 v[48:63], a[140:143], a[16:19], 0
    s_add_u32 m0, s70, 24576
    s_add_u32 s80, s51, 0
    buffer_load_dwordx4 v5, s[12:15], s80 offen offset:0 lds
    buffer_load_dwordx4 v6, s[12:15], s80 offen offset:1024 lds
    buffer_load_dwordx4 v7, s[12:15], s80 offen offset:2048 lds
    buffer_load_dwordx4 v8, s[12:15], s80 offen offset:3072 lds
    s_waitcnt vmcnt(16)
    ds_read_b128 a[32:35], v18 offset:8192
    ds_read_b128 a[36:39], v19 offset:8192
    ds_read_b128 a[40:43], v20 offset:8192
    ds_read_b128 a[44:47], v21 offset:8192
    s_waitcnt lgkmcnt(0)
    v_mfma_f32_32x32x16_bf16 v[64:79], a[128:131], a[32:35], 0
    v_mfma_f32_32x32x16_bf16 v[80:95], a[132:135], a[32:35], 0
    v_mfma_f32_32x32x16_bf16 v[96:111], a[136:139], a[32:35], 0
    v_mfma_f32_32x32x16_bf16 v[112:127], a[140:143], a[32:35], 0
    s_add_u32 m0, s70, 28672
    s_add_u32 s80, s71, 524288
    buffer_load_dwordx4 v5, s[12:15], s80 offen offset:0 lds
    buffer_load_dwordx4 v6, s[12:15], s80 offen offset:1024 lds
    buffer_load_dwordx4 v7, s[12:15], s80 offen offset:2048 lds
    buffer_load_dwordx4 v8, s[12:15], s80 offen offset:3072 lds
    s_waitcnt vmcnt(16)
    ds_read_b64_tr_b16 a[144:145], v22 offset:12288
    ds_read_b64_tr_b16 a[146:147], v22 offset:13312
    ds_read_b64_tr_b16 a[148:149], v23 offset:12288
    ds_read_b64_tr_b16 a[150:151], v23 offset:13312
    ds_read_b64_tr_b16 a[152:153], v24 offset:12288
    ds_read_b64_tr_b16 a[154:155], v24 offset:13312
    ds_read_b64_tr_b16 a[156:157], v25 offset:12288
    ds_read_b64_tr_b16 a[158:159], v25 offset:13312
    s_waitcnt lgkmcnt(0)
    v_mfma_f32_32x32x16_bf16 a[160:175], a[144:147], a[20:23], a[160:175]
    v_mfma_f32_32x32x16_bf16 a[176:191], a[148:151], a[20:23], a[176:191]
    v_mfma_f32_32x32x16_bf16 v[32:47], a[152:155], a[20:23], v[32:47]
    v_mfma_f32_32x32x16_bf16 v[48:63], a[156:159], a[20:23], v[48:63]
    v_mfma_f32_32x32x16_bf16 v[64:79], a[144:147], a[36:39], v[64:79]
    v_mfma_f32_32x32x16_bf16 v[80:95], a[148:151], a[36:39], v[80:95]
    v_mfma_f32_32x32x16_bf16 v[96:111], a[152:155], a[36:39], v[96:111]
    v_mfma_f32_32x32x16_bf16 v[112:127], a[156:159], a[36:39], v[112:127]
    s_add_u32 m0, s70, 32768
    s_and_b32 s81, s6, 7
    s_lshl_b32 s81, s81, 15
    s_add_u32 s80, s81, 256
    buffer_load_dwordx4 v1, s[8:11], s80 offen offset:0 lds
    buffer_load_dwordx4 v2, s[8:11], s80 offen offset:1024 lds
    s_waitcnt vmcnt(14)
    ds_read_b128 a[48:51], v18 offset:16384
    ds_read_b128 a[52:55], v19 offset:16384
    ds_read_b128 a[56:59], v20 offset:16384
    ds_read_b128 a[60:63], v21 offset:16384
    s_waitcnt lgkmcnt(0)
    v_mfma_f32_32x32x16_bf16 v[128:143], a[128:131], a[48:51], 0
    v_mfma_f32_32x32x16_bf16 v[144:159], a[132:135], a[48:51], 0
    v_mfma_f32_32x32x16_bf16 v[160:175], a[136:139], a[48:51], 0
    v_mfma_f32_32x32x16_bf16 v[176:191], a[140:143], a[48:51], 0
    v_mfma_f32_32x32x16_bf16 v[128:143], a[144:147], a[52:55], v[128:143]
    v_mfma_f32_32x32x16_bf16 v[144:159], a[148:151], a[52:55], v[144:159]
    v_mfma_f32_32x32x16_bf16 v[160:175], a[152:155], a[52:55], v[160:175]
    v_mfma_f32_32x32x16_bf16 v[176:191], a[156:159], a[52:55], v[176:191]
    s_add_u32 m0, s70, 36864
    s_add_u32 s80, s52, 0
    buffer_load_dwordx4 v5, s[12:15], s80 offen offset:0 lds
    buffer_load_dwordx4 v6, s[12:15], s80 offen offset:1024 lds
    buffer_load_dwordx4 v7, s[12:15], s80 offen offset:2048 lds
    buffer_load_dwordx4 v8, s[12:15], s80 offen offset:3072 lds
    s_waitcnt vmcnt(14)
    ds_read_b128 a[0:3], v18 offset:20480
    ds_read_b128 a[4:7], v19 offset:20480
    ds_read_b128 a[8:11], v20 offset:20480
    ds_read_b128 a[12:15], v21 offset:20480
    s_waitcnt lgkmcnt(0)
    v_mfma_f32_32x32x16_bf16 v[192:207], a[128:131], a[0:3], 0
    v_mfma_f32_32x32x16_bf16 v[208:223], a[132:135], a[0:3], 0
    v_mfma_f32_32x32x16_bf16 v[224:239], a[136:139], a[0:3], 0
    v_mfma_f32_32x32x16_bf16 v[240:255], a[140:143], a[0:3], 0
    v_mfma_f32_32x32x16_bf16 v[192:207], a[144:147], a[4:7], v[192:207]
    v_mfma_f32_32x32x16_bf16 v[208:223], a[148:151], a[4:7], v[208:223]
    v_mfma_f32_32x32x16_bf16 v[224:239], a[152:155], a[4:7], v[224:239]
    v_mfma_f32_32x32x16_bf16 v[240:255], a[156:159], a[4:7], v[240:255]
    s_add_u32 m0, s70, 0
    s_add_u32 s80, s73, 128
    buffer_load_dwordx4 v1, s[8:11], s80 offen offset:0 lds
    buffer_load_dwordx4 v2, s[8:11], s80 offen offset:1024 lds
    buffer_load_dwordx4 v3, s[8:11], s80 offen offset:2048 lds
    buffer_load_dwordx4 v4, s[8:11], s80 offen offset:3072 lds
    s_waitcnt vmcnt(14)
    ds_read_b64_tr_b16 a[192:193], v22 offset:24576
    ds_read_b64_tr_b16 a[194:195], v22 offset:25600
    ds_read_b64_tr_b16 a[196:197], v23 offset:24576
    ds_read_b64_tr_b16 a[198:199], v23 offset:25600
    ds_read_b64_tr_b16 a[200:201], v24 offset:24576
    ds_read_b64_tr_b16 a[202:203], v24 offset:25600
    ds_read_b64_tr_b16 a[204:205], v25 offset:24576
    ds_read_b64_tr_b16 a[206:207], v25 offset:25600
    s_waitcnt lgkmcnt(0)
    v_mfma_f32_32x32x16_bf16 a[160:175], a[192:195], a[24:27], a[160:175]
    s_add_u32 m0, s70, 4096
    s_add_u32 s80, s74, 128
    buffer_load_dwordx4 v1, s[8:11], s80 offen offset:0 lds
    buffer_load_dwordx4 v2, s[8:11], s80 offen offset:1024 lds
    v_mfma_f32_32x32x16_bf16 a[176:191], a[196:199], a[24:27], a[176:191]
    buffer_load_dwordx4 v3, s[8:11], s80 offen offset:2048 lds
    buffer_load_dwordx4 v4, s[8:11], s80 offen offset:3072 lds
    v_mfma_f32_32x32x16_bf16 v[32:47], a[200:203], a[24:27], v[32:47]
    s_add_u32 m0, s70, 8192
    s_add_u32 s80, s75, 128
    buffer_load_dwordx4 v1, s[8:11], s80 offen offset:0 lds
    buffer_load_dwordx4 v2, s[8:11], s80 offen offset:1024 lds
    v_mfma_f32_32x32x16_bf16 v[48:63], a[204:207], a[24:27], v[48:63]
    buffer_load_dwordx4 v3, s[8:11], s80 offen offset:2048 lds
    buffer_load_dwordx4 v4, s[8:11], s80 offen offset:3072 lds
    v_mfma_f32_32x32x16_bf16 v[64:79], a[192:195], a[40:43], v[64:79]
    s_add_u32 m0, s70, 12288
    s_add_u32 s80, s72, 128
    buffer_load_dwordx4 v1, s[8:11], s80 offen offset:0 lds
    buffer_load_dwordx4 v2, s[8:11], s80 offen offset:1024 lds
    v_mfma_f32_32x32x16_bf16 v[80:95], a[196:199], a[40:43], v[80:95]
    buffer_load_dwordx4 v3, s[8:11], s80 offen offset:2048 lds
    buffer_load_dwordx4 v4, s[8:11], s80 offen offset:3072 lds
    v_mfma_f32_32x32x16_bf16 v[96:111], a[200:203], a[40:43], v[96:111]
    s_add_u32 m0, s70, 16384
    s_add_u32 s80, s71, 1048576
    buffer_load_dwordx4 v5, s[12:15], s80 offen offset:0 lds
    buffer_load_dwordx4 v6, s[12:15], s80 offen offset:1024 lds
    s_waitcnt vmcnt(10)
    ds_read_b64_tr_b16 a[144:145], v22 offset:36864
    ds_read_b64_tr_b16 a[146:147], v22 offset:37888
    v_mfma_f32_32x32x16_bf16 v[112:127], a[204:207], a[40:43], v[112:127]
    buffer_load_dwordx4 v7, s[12:15], s80 offen offset:2048 lds
    buffer_load_dwordx4 v8, s[12:15], s80 offen offset:3072 lds
    ds_read_b64_tr_b16 a[148:149], v23 offset:36864
    ds_read_b64_tr_b16 a[150:151], v23 offset:37888
    v_mfma_f32_32x32x16_bf16 v[128:143], a[192:195], a[56:59], v[128:143]
    ds_read_b64_tr_b16 a[152:153], v24 offset:36864
    ds_read_b64_tr_b16 a[154:155], v24 offset:37888
    v_mfma_f32_32x32x16_bf16 v[144:159], a[196:199], a[56:59], v[144:159]
    ds_read_b64_tr_b16 a[156:157], v25 offset:36864
    ds_read_b64_tr_b16 a[158:159], v25 offset:37888
    v_mfma_f32_32x32x16_bf16 v[160:175], a[200:203], a[56:59], v[160:175]
    ds_read_b128 a[80:83], v18 offset:0
    ds_read_b128 a[84:87], v19 offset:0
    v_mfma_f32_32x32x16_bf16 v[176:191], a[204:207], a[56:59], v[176:191]
    ds_read_b128 a[88:91], v20 offset:0
    ds_read_b128 a[92:95], v21 offset:0
    v_mfma_f32_32x32x16_bf16 v[192:207], a[192:195], a[8:11], v[192:207]
    ds_read_b128 a[96:99], v18 offset:4096
    ds_read_b128 a[100:103], v19 offset:4096
    v_mfma_f32_32x32x16_bf16 v[208:223], a[196:199], a[8:11], v[208:223]
    ds_read_b128 a[104:107], v20 offset:4096
    ds_read_b128 a[108:111], v21 offset:4096
    v_mfma_f32_32x32x16_bf16 v[224:239], a[200:203], a[8:11], v[224:239]
    v_mfma_f32_32x32x16_bf16 v[240:255], a[204:207], a[8:11], v[240:255]
    s_waitcnt lgkmcnt(0)
    v_mfma_f32_32x32x16_bf16 a[160:175], a[144:147], a[28:31], a[160:175]
    s_add_u32 m0, s70, 20480
    s_and_b32 s81, s6, 7
    s_lshl_b32 s81, s81, 15
    s_add_u32 s80, s81, 384
    buffer_load_dwordx4 v1, s[8:11], s80 offen offset:0 lds
    buffer_load_dwordx4 v2, s[8:11], s80 offen offset:1024 lds
    v_mfma_f32_32x32x16_bf16 a[176:191], a[148:151], a[28:31], a[176:191]
    s_add_u32 m0, s70, 24576
    s_add_u32 s80, s50, 524288
    buffer_load_dwordx4 v5, s[12:15], s80 offen offset:0 lds
    buffer_load_dwordx4 v6, s[12:15], s80 offen offset:1024 lds
    v_mfma_f32_32x32x16_bf16 v[32:47], a[152:155], a[28:31], v[32:47]
    buffer_load_dwordx4 v7, s[12:15], s80 offen offset:2048 lds
    buffer_load_dwordx4 v8, s[12:15], s80 offen offset:3072 lds
    v_mfma_f32_32x32x16_bf16 v[48:63], a[156:159], a[28:31], v[48:63]
    s_add_u32 m0, s70, 32768
    s_add_u32 s80, s72, 256
    buffer_load_dwordx4 v1, s[8:11], s80 offen offset:0 lds
    v_mfma_f32_32x32x16_bf16 v[64:79], a[144:147], a[44:47], v[64:79]
    buffer_load_dwordx4 v2, s[8:11], s80 offen offset:1024 lds
    buffer_load_dwordx4 v3, s[8:11], s80 offen offset:2048 lds
    v_mfma_f32_32x32x16_bf16 v[80:95], a[148:151], a[44:47], v[80:95]
    buffer_load_dwordx4 v4, s[8:11], s80 offen offset:3072 lds
    s_add_u32 m0, s70, 36864
    s_add_u32 s80, s51, 524288
    buffer_load_dwordx4 v5, s[12:15], s80 offen offset:0 lds
    v_mfma_f32_32x32x16_bf16 v[96:111], a[152:155], a[44:47], v[96:111]
    buffer_load_dwordx4 v6, s[12:15], s80 offen offset:1024 lds
    buffer_load_dwordx4 v7, s[12:15], s80 offen offset:2048 lds
    s_waitcnt vmcnt(17)
    ds_read_b64_tr_b16 a[128:129], v22 offset:28672
    ds_read_b64_tr_b16 a[130:131], v22 offset:29696
    v_mfma_f32_32x32x16_bf16 v[112:127], a[156:159], a[44:47], v[112:127]
    buffer_load_dwordx4 v8, s[12:15], s80 offen offset:3072 lds
    ds_read_b64_tr_b16 a[132:133], v23 offset:28672
    ds_read_b64_tr_b16 a[134:135], v23 offset:29696
    v_mfma_f32_32x32x16_bf16 v[128:143], a[144:147], a[60:63], v[128:143]
    ds_read_b64_tr_b16 a[136:137], v24 offset:28672
    ds_read_b64_tr_b16 a[138:139], v24 offset:29696
    v_mfma_f32_32x32x16_bf16 v[144:159], a[148:151], a[60:63], v[144:159]
    ds_read_b64_tr_b16 a[140:141], v25 offset:28672
    ds_read_b64_tr_b16 a[142:143], v25 offset:29696
    v_mfma_f32_32x32x16_bf16 v[160:175], a[152:155], a[60:63], v[160:175]
    ds_read_b128 a[112:115], v18 offset:8192
    ds_read_b128 a[116:119], v19 offset:8192
    v_mfma_f32_32x32x16_bf16 v[176:191], a[156:159], a[60:63], v[176:191]
    ds_read_b128 a[120:123], v20 offset:8192
    ds_read_b128 a[124:127], v21 offset:8192
    v_mfma_f32_32x32x16_bf16 v[192:207], a[144:147], a[12:15], v[192:207]
    ds_read_b128 a[64:67], v18 offset:12288
    ds_read_b128 a[68:71], v19 offset:12288
    v_mfma_f32_32x32x16_bf16 v[208:223], a[148:151], a[12:15], v[208:223]
    ds_read_b128 a[72:75], v20 offset:12288
    ds_read_b128 a[76:79], v21 offset:12288
    v_mfma_f32_32x32x16_bf16 v[224:239], a[152:155], a[12:15], v[224:239]
    v_mfma_f32_32x32x16_bf16 v[240:255], a[156:159], a[12:15], v[240:255]
    s_waitcnt lgkmcnt(0)
    v_mfma_f32_32x32x16_bf16 a[160:175], a[128:131], a[80:83], a[160:175]
    s_add_u32 m0, s70, 0
    s_add_u32 s80, s73, 256
    buffer_load_dwordx4 v1, s[8:11], s80 offen offset:0 lds
    buffer_load_dwordx4 v2, s[8:11], s80 offen offset:1024 lds
    v_mfma_f32_32x32x16_bf16 a[176:191], a[132:135], a[80:83], a[176:191]
    buffer_load_dwordx4 v3, s[8:11], s80 offen offset:2048 lds
    buffer_load_dwordx4 v4, s[8:11], s80 offen offset:3072 lds
    v_mfma_f32_32x32x16_bf16 v[32:47], a[136:139], a[80:83], v[32:47]
    s_add_u32 m0, s70, 4096
    s_add_u32 s80, s52, 524288
    buffer_load_dwordx4 v5, s[12:15], s80 offen offset:0 lds
    buffer_load_dwordx4 v6, s[12:15], s80 offen offset:1024 lds
    v_mfma_f32_32x32x16_bf16 v[48:63], a[140:143], a[80:83], v[48:63]
    buffer_load_dwordx4 v7, s[12:15], s80 offen offset:2048 lds
    buffer_load_dwordx4 v8, s[12:15], s80 offen offset:3072 lds
    v_mfma_f32_32x32x16_bf16 v[64:79], a[128:131], a[96:99], v[64:79]
    s_add_u32 m0, s70, 28672
    s_add_u32 s80, s74, 256
    buffer_load_dwordx4 v1, s[8:11], s80 offen offset:0 lds
    buffer_load_dwordx4 v2, s[8:11], s80 offen offset:1024 lds
    v_mfma_f32_32x32x16_bf16 v[80:95], a[132:135], a[96:99], v[80:95]
    buffer_load_dwordx4 v3, s[8:11], s80 offen offset:2048 lds
    buffer_load_dwordx4 v4, s[8:11], s80 offen offset:3072 lds
    v_mfma_f32_32x32x16_bf16 v[96:111], a[136:139], a[96:99], v[96:111]
    s_add_u32 m0, s70, 8192
    s_add_u32 s80, s75, 256
    buffer_load_dwordx4 v1, s[8:11], s80 offen offset:0 lds
    buffer_load_dwordx4 v2, s[8:11], s80 offen offset:1024 lds
    v_mfma_f32_32x32x16_bf16 v[112:127], a[140:143], a[96:99], v[112:127]
    buffer_load_dwordx4 v3, s[8:11], s80 offen offset:2048 lds
    buffer_load_dwordx4 v4, s[8:11], s80 offen offset:3072 lds
    v_mfma_f32_32x32x16_bf16 v[128:143], a[128:131], a[112:115], v[128:143]
    s_waitcnt vmcnt(20)
    ds_read_b64_tr_b16 a[144:145], v22 offset:24576
    ds_read_b64_tr_b16 a[146:147], v22 offset:25600
    v_mfma_f32_32x32x16_bf16 v[144:159], a[132:135], a[112:115], v[144:159]
    ds_read_b64_tr_b16 a[148:149], v23 offset:24576
    ds_read_b64_tr_b16 a[150:151], v23 offset:25600
    v_mfma_f32_32x32x16_bf16 v[160:175], a[136:139], a[112:115], v[160:175]
    ds_read_b64_tr_b16 a[152:153], v24 offset:24576
    ds_read_b64_tr_b16 a[154:155], v24 offset:25600
    v_mfma_f32_32x32x16_bf16 v[176:191], a[140:143], a[112:115], v[176:191]
    ds_read_b64_tr_b16 a[156:157], v25 offset:24576
    ds_read_b64_tr_b16 a[158:159], v25 offset:25600
    v_mfma_f32_32x32x16_bf16 v[192:207], a[128:131], a[64:67], v[192:207]
    ds_read_b128 a[0:3], v18 offset:32768
    ds_read_b128 a[4:7], v19 offset:32768
    v_mfma_f32_32x32x16_bf16 v[208:223], a[132:135], a[64:67], v[208:223]
    ds_read_b128 a[8:11], v20 offset:32768
    ds_read_b128 a[12:15], v21 offset:32768
    v_mfma_f32_32x32x16_bf16 v[224:239], a[136:139], a[64:67], v[224:239]
    v_mfma_f32_32x32x16_bf16 v[240:255], a[140:143], a[64:67], v[240:255]
    s_waitcnt lgkmcnt(0)
    v_mfma_f32_32x32x16_bf16 a[160:175], a[144:147], a[84:87], a[160:175]
    s_add_u32 m0, s70, 12288
    s_add_u32 s80, s71, 1572864
    buffer_load_dwordx4 v5, s[12:15], s80 offen offset:0 lds
    v_mfma_f32_32x32x16_bf16 a[176:191], a[148:151], a[84:87], a[176:191]
    buffer_load_dwordx4 v6, s[12:15], s80 offen offset:1024 lds
    v_mfma_f32_32x32x16_bf16 v[32:47], a[152:155], a[84:87], v[32:47]
    buffer_load_dwordx4 v7, s[12:15], s80 offen offset:2048 lds
    v_mfma_f32_32x32x16_bf16 v[48:63], a[156:159], a[84:87], v[48:63]
    buffer_load_dwordx4 v8, s[12:15], s80 offen offset:3072 lds
    v_mfma_f32_32x32x16_bf16 v[64:79], a[144:147], a[100:103], v[64:79]
    s_add_u32 m0, s70, 20480
    s_add_u32 s80, s90, 0
    buffer_load_dwordx4 v13, s[24:27], s80 offen offset:0 lds
    v_mfma_f32_32x32x16_bf16 v[80:95], a[148:151], a[100:103], v[80:95]
    buffer_load_dwordx4 v14, s[24:27], s80 offen offset:1024 lds
    v_mfma_f32_32x32x16_bf16 v[96:111], a[152:155], a[100:103], v[96:111]
    buffer_load_dwordx4 v15, s[24:27], s80 offen offset:2048 lds
    v_mfma_f32_32x32x16_bf16 v[112:127], a[156:159], a[100:103], v[112:127]
    buffer_load_dwordx4 v16, s[24:27], s80 offen offset:3072 lds
    v_mfma_f32_32x32x16_bf16 v[128:143], a[144:147], a[116:119], v[128:143]
    s_waitcnt vmcnt(20)
    ds_read_b64_tr_b16 a[128:129], v22 offset:36864
    ds_read_b64_tr_b16 a[130:131], v22 offset:37888
    v_mfma_f32_32x32x16_bf16 v[144:159], a[148:151], a[116:119], v[144:159]
    ds_read_b64_tr_b16 a[132:133], v23 offset:36864
    ds_read_b64_tr_b16 a[134:135], v23 offset:37888
    v_mfma_f32_32x32x16_bf16 v[160:175], a[152:155], a[116:119], v[160:175]
    ds_read_b64_tr_b16 a[136:137], v24 offset:36864
    ds_read_b64_tr_b16 a[138:139], v24 offset:37888
    v_mfma_f32_32x32x16_bf16 v[176:191], a[156:159], a[116:119], v[176:191]
    ds_read_b64_tr_b16 a[140:141], v25 offset:36864
    ds_read_b64_tr_b16 a[142:143], v25 offset:37888
    v_mfma_f32_32x32x16_bf16 v[192:207], a[144:147], a[68:71], v[192:207]
    ds_read_b128 a[16:19], v18 offset:0
    ds_read_b128 a[20:23], v19 offset:0
    v_mfma_f32_32x32x16_bf16 v[208:223], a[148:151], a[68:71], v[208:223]
    ds_read_b128 a[24:27], v20 offset:0
    ds_read_b128 a[28:31], v21 offset:0
    v_mfma_f32_32x32x16_bf16 v[224:239], a[152:155], a[68:71], v[224:239]
    v_mfma_f32_32x32x16_bf16 v[240:255], a[156:159], a[68:71], v[240:255]
    s_waitcnt lgkmcnt(0)
    v_mfma_f32_32x32x16_bf16 a[160:175], a[128:131], a[88:91], a[160:175]
    s_add_u32 m0, s70, 24576
    s_add_u32 s80, s50, 1048576
    buffer_load_dwordx4 v5, s[12:15], s80 offen offset:0 lds
    v_mfma_f32_32x32x16_bf16 a[176:191], a[132:135], a[88:91], a[176:191]
    buffer_load_dwordx4 v6, s[12:15], s80 offen offset:1024 lds
    v_mfma_f32_32x32x16_bf16 v[32:47], a[136:139], a[88:91], v[32:47]
    buffer_load_dwordx4 v7, s[12:15], s80 offen offset:2048 lds
    v_mfma_f32_32x32x16_bf16 v[48:63], a[140:143], a[88:91], v[48:63]
    buffer_load_dwordx4 v8, s[12:15], s80 offen offset:3072 lds
    v_mfma_f32_32x32x16_bf16 v[64:79], a[128:131], a[104:107], v[64:79]
    s_add_u32 m0, s70, 32768
    s_add_u32 s80, s72, 384
    buffer_load_dwordx4 v1, s[8:11], s80 offen offset:0 lds
    v_mfma_f32_32x32x16_bf16 v[80:95], a[132:135], a[104:107], v[80:95]
    buffer_load_dwordx4 v2, s[8:11], s80 offen offset:1024 lds
    v_mfma_f32_32x32x16_bf16 v[96:111], a[136:139], a[104:107], v[96:111]
    buffer_load_dwordx4 v3, s[8:11], s80 offen offset:2048 lds
    v_mfma_f32_32x32x16_bf16 v[112:127], a[140:143], a[104:107], v[112:127]
    buffer_load_dwordx4 v4, s[8:11], s80 offen offset:3072 lds
    v_mfma_f32_32x32x16_bf16 v[128:143], a[128:131], a[120:123], v[128:143]
    s_waitcnt vmcnt(20)
    ds_read_b64_tr_b16 a[144:145], v22 offset:4096
    ds_read_b64_tr_b16 a[146:147], v22 offset:5120
    v_mfma_f32_32x32x16_bf16 v[144:159], a[132:135], a[120:123], v[144:159]
    ds_read_b64_tr_b16 a[148:149], v23 offset:4096
    ds_read_b64_tr_b16 a[150:151], v23 offset:5120
    v_mfma_f32_32x32x16_bf16 v[160:175], a[136:139], a[120:123], v[160:175]
    ds_read_b64_tr_b16 a[152:153], v24 offset:4096
    ds_read_b64_tr_b16 a[154:155], v24 offset:5120
    v_mfma_f32_32x32x16_bf16 v[176:191], a[140:143], a[120:123], v[176:191]
    ds_read_b64_tr_b16 a[156:157], v25 offset:4096
    ds_read_b64_tr_b16 a[158:159], v25 offset:5120
    v_mfma_f32_32x32x16_bf16 v[192:207], a[128:131], a[72:75], v[192:207]
    ds_read_b128 a[32:35], v18 offset:28672
    ds_read_b128 a[36:39], v19 offset:28672
    v_mfma_f32_32x32x16_bf16 v[208:223], a[132:135], a[72:75], v[208:223]
    ds_read_b128 a[40:43], v20 offset:28672
    ds_read_b128 a[44:47], v21 offset:28672
    v_mfma_f32_32x32x16_bf16 v[224:239], a[136:139], a[72:75], v[224:239]
    v_mfma_f32_32x32x16_bf16 v[240:255], a[140:143], a[72:75], v[240:255]
    s_waitcnt lgkmcnt(0)
    v_mfma_f32_32x32x16_bf16 a[160:175], a[144:147], a[92:95], a[160:175]
    s_add_u32 m0, s70, 36864
    s_add_u32 s80, s51, 1048576
    buffer_load_dwordx4 v5, s[12:15], s80 offen offset:0 lds
    v_mfma_f32_32x32x16_bf16 a[176:191], a[148:151], a[92:95], a[176:191]
    v_mfma_f32_32x32x16_bf16 v[32:47], a[152:155], a[92:95], v[32:47]
    buffer_load_dwordx4 v6, s[12:15], s80 offen offset:1024 lds
    v_mfma_f32_32x32x16_bf16 v[48:63], a[156:159], a[92:95], v[48:63]
    v_mfma_f32_32x32x16_bf16 v[64:79], a[144:147], a[108:111], v[64:79]
    buffer_load_dwordx4 v7, s[12:15], s80 offen offset:2048 lds
    v_mfma_f32_32x32x16_bf16 v[80:95], a[148:151], a[108:111], v[80:95]
    v_mfma_f32_32x32x16_bf16 v[96:111], a[152:155], a[108:111], v[96:111]
    buffer_load_dwordx4 v8, s[12:15], s80 offen offset:3072 lds
    v_mfma_f32_32x32x16_bf16 v[112:127], a[156:159], a[108:111], v[112:127]
    v_mfma_f32_32x32x16_bf16 v[128:143], a[144:147], a[124:127], v[128:143]
    s_waitcnt vmcnt(20)
    ds_read_b64_tr_b16 a[128:129], v22 offset:16384
    ds_read_b64_tr_b16 a[130:131], v22 offset:17408
    v_mfma_f32_32x32x16_bf16 v[144:159], a[148:151], a[124:127], v[144:159]
    ds_read_b64_tr_b16 a[132:133], v23 offset:16384
    ds_read_b64_tr_b16 a[134:135], v23 offset:17408
    v_mfma_f32_32x32x16_bf16 v[160:175], a[152:155], a[124:127], v[160:175]
    ds_read_b64_tr_b16 a[136:137], v24 offset:16384
    ds_read_b64_tr_b16 a[138:139], v24 offset:17408
    v_mfma_f32_32x32x16_bf16 v[176:191], a[156:159], a[124:127], v[176:191]
    ds_read_b64_tr_b16 a[140:141], v25 offset:16384
    ds_read_b64_tr_b16 a[142:143], v25 offset:17408
    v_mfma_f32_32x32x16_bf16 v[192:207], a[144:147], a[76:79], v[192:207]
    ds_read_b128 a[48:51], v18 offset:8192
    ds_read_b128 a[52:55], v19 offset:8192
    v_mfma_f32_32x32x16_bf16 v[208:223], a[148:151], a[76:79], v[208:223]
    ds_read_b128 a[56:59], v20 offset:8192
    ds_read_b128 a[60:63], v21 offset:8192
    v_mfma_f32_32x32x16_bf16 v[224:239], a[152:155], a[76:79], v[224:239]
    v_mfma_f32_32x32x16_bf16 v[240:255], a[156:159], a[76:79], v[240:255]
    s_waitcnt lgkmcnt(0)
    buffer_load_dword v30, off, s[64:67], s79 sc1
    v_mfma_f32_32x32x16_bf16 a[160:175], a[128:131], a[16:19], a[160:175]
    s_add_u32 m0, s70, 0
    s_add_u32 s80, s73, 384
    buffer_load_dwordx4 v1, s[8:11], s80 offen offset:0 lds
    buffer_load_dwordx4 v2, s[8:11], s80 offen offset:1024 lds
    v_mfma_f32_32x32x16_bf16 a[176:191], a[132:135], a[16:19], a[176:191]
    buffer_load_dwordx4 v3, s[8:11], s80 offen offset:2048 lds
    buffer_load_dwordx4 v4, s[8:11], s80 offen offset:3072 lds
    v_mfma_f32_32x32x16_bf16 v[32:47], a[136:139], a[16:19], v[32:47]
    s_add_u32 m0, s70, 4096
    s_add_u32 s80, s52, 1048576
    buffer_load_dwordx4 v5, s[12:15], s80 offen offset:0 lds
    buffer_load_dwordx4 v6, s[12:15], s80 offen offset:1024 lds
    v_mfma_f32_32x32x16_bf16 v[48:63], a[140:143], a[16:19], v[48:63]
    buffer_load_dwordx4 v7, s[12:15], s80 offen offset:2048 lds
    buffer_load_dwordx4 v8, s[12:15], s80 offen offset:3072 lds
    v_mfma_f32_32x32x16_bf16 v[64:79], a[128:131], a[32:35], v[64:79]
    s_add_u32 m0, s70, 28672
    s_add_u32 s80, s74, 384
    buffer_load_dwordx4 v1, s[8:11], s80 offen offset:0 lds
    buffer_load_dwordx4 v2, s[8:11], s80 offen offset:1024 lds
    v_mfma_f32_32x32x16_bf16 v[80:95], a[132:135], a[32:35], v[80:95]
    buffer_load_dwordx4 v3, s[8:11], s80 offen offset:2048 lds
    buffer_load_dwordx4 v4, s[8:11], s80 offen offset:3072 lds
    v_mfma_f32_32x32x16_bf16 v[96:111], a[136:139], a[32:35], v[96:111]
    s_add_u32 m0, s70, 16384
    s_add_u32 s80, s75, 384
    buffer_load_dwordx4 v1, s[8:11], s80 offen offset:0 lds
    buffer_load_dwordx4 v2, s[8:11], s80 offen offset:1024 lds
    v_mfma_f32_32x32x16_bf16 v[112:127], a[140:143], a[32:35], v[112:127]
    buffer_load_dwordx4 v3, s[8:11], s80 offen offset:2048 lds
    buffer_load_dwordx4 v4, s[8:11], s80 offen offset:3072 lds
    v_mfma_f32_32x32x16_bf16 v[128:143], a[128:131], a[48:51], v[128:143]
    s_waitcnt vmcnt(21)
    ds_read_b64_tr_b16 a[144:145], v22 offset:24576
    ds_read_b64_tr_b16 a[146:147], v22 offset:25600
    v_mfma_f32_32x32x16_bf16 v[144:159], a[132:135], a[48:51], v[144:159]
    ds_read_b64_tr_b16 a[148:149], v23 offset:24576
    ds_read_b64_tr_b16 a[150:151], v23 offset:25600
    v_mfma_f32_32x32x16_bf16 v[160:175], a[136:139], a[48:51], v[160:175]
    ds_read_b64_tr_b16 a[152:153], v24 offset:24576
    ds_read_b64_tr_b16 a[154:155], v24 offset:25600
    v_mfma_f32_32x32x16_bf16 v[176:191], a[140:143], a[48:51], v[176:191]
    ds_read_b64_tr_b16 a[156:157], v25 offset:24576
    ds_read_b64_tr_b16 a[158:159], v25 offset:25600
    v_mfma_f32_32x32x16_bf16 v[192:207], a[128:131], a[0:3], v[192:207]
    ds_read_b128 a[64:67], v18 offset:32768
    ds_read_b128 a[68:71], v19 offset:32768
    v_mfma_f32_32x32x16_bf16 v[208:223], a[132:135], a[0:3], v[208:223]
    ds_read_b128 a[72:75], v20 offset:32768
    ds_read_b128 a[76:79], v21 offset:32768
    v_mfma_f32_32x32x16_bf16 v[224:239], a[136:139], a[0:3], v[224:239]
    v_mfma_f32_32x32x16_bf16 v[240:255], a[140:143], a[0:3], v[240:255]
    s_waitcnt lgkmcnt(0)
    v_mfma_f32_32x32x16_bf16 a[160:175], a[144:147], a[20:23], a[160:175]
    s_add_u32 m0, s70, 8192
    s_add_u32 s80, s90, 65536
    buffer_load_dwordx4 v13, s[24:27], s80 offen offset:0 lds
    v_mfma_f32_32x32x16_bf16 a[176:191], a[148:151], a[20:23], a[176:191]
    buffer_load_dwordx4 v14, s[24:27], s80 offen offset:1024 lds
    v_mfma_f32_32x32x16_bf16 v[32:47], a[152:155], a[20:23], v[32:47]
    buffer_load_dwordx4 v15, s[24:27], s80 offen offset:2048 lds
    v_mfma_f32_32x32x16_bf16 v[48:63], a[156:159], a[20:23], v[48:63]
    buffer_load_dwordx4 v16, s[24:27], s80 offen offset:3072 lds
    v_mfma_f32_32x32x16_bf16 v[64:79], a[144:147], a[36:39], v[64:79]
    s_add_u32 m0, s70, 24576
    s_add_u32 s80, s50, 1572864
    buffer_load_dwordx4 v5, s[12:15], s80 offen offset:0 lds
    v_mfma_f32_32x32x16_bf16 v[80:95], a[148:151], a[36:39], v[80:95]
    buffer_load_dwordx4 v6, s[12:15], s80 offen offset:1024 lds
    v_mfma_f32_32x32x16_bf16 v[96:111], a[152:155], a[36:39], v[96:111]
    buffer_load_dwordx4 v7, s[12:15], s80 offen offset:2048 lds
    v_mfma_f32_32x32x16_bf16 v[112:127], a[156:159], a[36:39], v[112:127]
    buffer_load_dwordx4 v8, s[12:15], s80 offen offset:3072 lds
    v_mfma_f32_32x32x16_bf16 v[128:143], a[144:147], a[52:55], v[128:143]
    s_waitcnt vmcnt(20)
    ds_read_b64_tr_b16 a[128:129], v22 offset:36864
    ds_read_b64_tr_b16 a[130:131], v22 offset:37888
    v_mfma_f32_32x32x16_bf16 v[144:159], a[148:151], a[52:55], v[144:159]
    ds_read_b64_tr_b16 a[132:133], v23 offset:36864
    ds_read_b64_tr_b16 a[134:135], v23 offset:37888
    v_mfma_f32_32x32x16_bf16 v[160:175], a[152:155], a[52:55], v[160:175]
    ds_read_b64_tr_b16 a[136:137], v24 offset:36864
    ds_read_b64_tr_b16 a[138:139], v24 offset:37888
    v_mfma_f32_32x32x16_bf16 v[176:191], a[156:159], a[52:55], v[176:191]
    ds_read_b64_tr_b16 a[140:141], v25 offset:36864
    ds_read_b64_tr_b16 a[142:143], v25 offset:37888
    v_mfma_f32_32x32x16_bf16 v[192:207], a[144:147], a[4:7], v[192:207]
    ds_read_b128 a[80:83], v18 offset:0
    ds_read_b128 a[84:87], v19 offset:0
    v_mfma_f32_32x32x16_bf16 v[208:223], a[148:151], a[4:7], v[208:223]
    ds_read_b128 a[88:91], v20 offset:0
    ds_read_b128 a[92:95], v21 offset:0
    v_mfma_f32_32x32x16_bf16 v[224:239], a[152:155], a[4:7], v[224:239]
    v_mfma_f32_32x32x16_bf16 v[240:255], a[156:159], a[4:7], v[240:255]
    s_waitcnt lgkmcnt(0)
    v_mfma_f32_32x32x16_bf16 a[160:175], a[128:131], a[24:27], a[160:175]
    s_add_u32 m0, s70, 32768
    s_add_u32 s80, s76, 0
    buffer_load_dwordx4 v9, s[16:19], s80 offen offset:0 lds
    v_mfma_f32_32x32x16_bf16 a[176:191], a[132:135], a[24:27], a[176:191]
    buffer_load_dwordx4 v10, s[16:19], s80 offen offset:1024 lds
    v_mfma_f32_32x32x16_bf16 v[32:47], a[136:139], a[24:27], v[32:47]
    buffer_load_dwordx4 v11, s[16:19], s80 offen offset:2048 lds
    v_mfma_f32_32x32x16_bf16 v[48:63], a[140:143], a[24:27], v[48:63]
    buffer_load_dwordx4 v12, s[16:19], s80 offen offset:3072 lds
    v_mfma_f32_32x32x16_bf16 v[64:79], a[128:131], a[40:43], v[64:79]
    s_add_u32 m0, s70, 36864
    s_add_u32 s80, s76, 128
    buffer_load_dwordx4 v9, s[16:19], s80 offen offset:0 lds
    v_mfma_f32_32x32x16_bf16 v[80:95], a[132:135], a[40:43], v[80:95]
    buffer_load_dwordx4 v10, s[16:19], s80 offen offset:1024 lds
    v_mfma_f32_32x32x16_bf16 v[96:111], a[136:139], a[40:43], v[96:111]
    buffer_load_dwordx4 v11, s[16:19], s80 offen offset:2048 lds
    v_mfma_f32_32x32x16_bf16 v[112:127], a[140:143], a[40:43], v[112:127]
    buffer_load_dwordx4 v12, s[16:19], s80 offen offset:3072 lds
    v_mfma_f32_32x32x16_bf16 v[128:143], a[128:131], a[56:59], v[128:143]
    s_waitcnt vmcnt(20)
    ds_read_b64_tr_b16 a[144:145], v22 offset:4096
    ds_read_b64_tr_b16 a[146:147], v22 offset:5120
    v_mfma_f32_32x32x16_bf16 v[144:159], a[132:135], a[56:59], v[144:159]
    ds_read_b64_tr_b16 a[148:149], v23 offset:4096
    ds_read_b64_tr_b16 a[150:151], v23 offset:5120
    v_mfma_f32_32x32x16_bf16 v[160:175], a[136:139], a[56:59], v[160:175]
    ds_read_b64_tr_b16 a[152:153], v24 offset:4096
    ds_read_b64_tr_b16 a[154:155], v24 offset:5120
    v_mfma_f32_32x32x16_bf16 v[176:191], a[140:143], a[56:59], v[176:191]
    ds_read_b64_tr_b16 a[156:157], v25 offset:4096
    ds_read_b64_tr_b16 a[158:159], v25 offset:5120
    v_mfma_f32_32x32x16_bf16 v[192:207], a[128:131], a[8:11], v[192:207]
    ds_read_b128 a[96:99], v18 offset:28672
    ds_read_b128 a[100:103], v19 offset:28672
    v_mfma_f32_32x32x16_bf16 v[208:223], a[132:135], a[8:11], v[208:223]
    ds_read_b128 a[104:107], v20 offset:28672
    ds_read_b128 a[108:111], v21 offset:28672
    v_mfma_f32_32x32x16_bf16 v[224:239], a[136:139], a[8:11], v[224:239]
    v_mfma_f32_32x32x16_bf16 v[240:255], a[140:143], a[8:11], v[240:255]
    s_waitcnt lgkmcnt(0)
    v_mfma_f32_32x32x16_bf16 a[160:175], a[144:147], a[28:31], a[160:175]
    s_add_u32 m0, s70, 0
    s_add_u32 s80, s51, 1572864
    buffer_load_dwordx4 v5, s[12:15], s80 offen offset:0 lds
    v_mfma_f32_32x32x16_bf16 a[176:191], a[148:151], a[28:31], a[176:191]
    v_mfma_f32_32x32x16_bf16 v[32:47], a[152:155], a[28:31], v[32:47]
    buffer_load_dwordx4 v6, s[12:15], s80 offen offset:1024 lds
    v_mfma_f32_32x32x16_bf16 v[48:63], a[156:159], a[28:31], v[48:63]
    v_mfma_f32_32x32x16_bf16 v[64:79], a[144:147], a[44:47], v[64:79]
    buffer_load_dwordx4 v7, s[12:15], s80 offen offset:2048 lds
    v_mfma_f32_32x32x16_bf16 v[80:95], a[148:151], a[44:47], v[80:95]
    v_mfma_f32_32x32x16_bf16 v[96:111], a[152:155], a[44:47], v[96:111]
    buffer_load_dwordx4 v8, s[12:15], s80 offen offset:3072 lds
    v_mfma_f32_32x32x16_bf16 v[112:127], a[156:159], a[44:47], v[112:127]
    v_mfma_f32_32x32x16_bf16 v[128:143], a[144:147], a[60:63], v[128:143]
    s_waitcnt vmcnt(20)
    ds_read_b64_tr_b16 a[128:129], v22 offset:12288
    ds_read_b64_tr_b16 a[130:131], v22 offset:13312
    v_mfma_f32_32x32x16_bf16 v[144:159], a[148:151], a[60:63], v[144:159]
    ds_read_b64_tr_b16 a[132:133], v23 offset:12288
    ds_read_b64_tr_b16 a[134:135], v23 offset:13312
    v_mfma_f32_32x32x16_bf16 v[160:175], a[152:155], a[60:63], v[160:175]
    ds_read_b64_tr_b16 a[136:137], v24 offset:12288
    ds_read_b64_tr_b16 a[138:139], v24 offset:13312
    v_mfma_f32_32x32x16_bf16 v[176:191], a[156:159], a[60:63], v[176:191]
    ds_read_b64_tr_b16 a[140:141], v25 offset:12288
    ds_read_b64_tr_b16 a[142:143], v25 offset:13312
    v_mfma_f32_32x32x16_bf16 v[192:207], a[144:147], a[12:15], v[192:207]
    ds_read_b128 a[112:115], v18 offset:16384
    ds_read_b128 a[116:119], v19 offset:16384
    v_mfma_f32_32x32x16_bf16 v[208:223], a[148:151], a[12:15], v[208:223]
    ds_read_b128 a[120:123], v20 offset:16384
    ds_read_b128 a[124:127], v21 offset:16384
    v_mfma_f32_32x32x16_bf16 v[224:239], a[152:155], a[12:15], v[224:239]
    v_mfma_f32_32x32x16_bf16 v[240:255], a[156:159], a[12:15], v[240:255]
    s_waitcnt lgkmcnt(0)
    v_xor_b32 v18, s40, v18
    v_xor_b32 v19, s40, v19
    v_xor_b32 v20, s40, v20
    v_xor_b32 v21, s40, v21
    s_waitcnt vmcnt(36)
    v_readfirstlane_b32 s83, v30
    s_cmp_lg_u32 s83, 0
    s_cbranch_scc1 L_gotn
    s_mov_b32 s82, 0
L_spinn:
    s_sleep 1
    buffer_load_dword v30, off, s[64:67], s79 sc1
    s_add_u32 s82, s82, 1
    s_waitcnt vmcnt(0)
    v_readfirstlane_b32 s83, v30
    s_cmp_lg_u32 s83, 0
    s_cbranch_scc1 L_gotn
    s_cmp_lt_u32 s82, 0x4000
    s_cbranch_scc1 L_spinn
L_gotn:
    v_mfma_f32_32x32x16_bf16 a[160:175], a[128:131], a[80:83], a[160:175]
    s_add_u32 m0, s70, 4096
    s_add_u32 s80, s52, 1572864
    buffer_load_dwordx4 v5, s[12:15], s80 offen offset:0 lds
    v_mfma_f32_32x32x16_bf16 a[176:191], a[132:135], a[80:83], a[176:191]
    buffer_load_dwordx4 v6, s[12:15], s80 offen offset:1024 lds
    v_mfma_f32_32x32x16_bf16 v[32:47], a[136:139], a[80:83], v[32:47]
    buffer_load_dwordx4 v7, s[12:15], s80 offen offset:2048 lds
    v_mfma_f32_32x32x16_bf16 v[48:63], a[140:143], a[80:83], v[48:63]
    buffer_load_dwordx4 v8, s[12:15], s80 offen offset:3072 lds
    v_mfma_f32_32x32x16_bf16 v[64:79], a[128:131], a[96:99], v[64:79]
    s_add_u32 m0, s70, 28672
    s_add_u32 s80, s90, 131072
    buffer_load_dwordx4 v13, s[24:27], s80 offen offset:0 lds
    v_mfma_f32_32x32x16_bf16 v[80:95], a[132:135], a[96:99], v[80:95]
    buffer_load_dwordx4 v14, s[24:27], s80 offen offset:1024 lds
    v_mfma_f32_32x32x16_bf16 v[96:111], a[136:139], a[96:99], v[96:111]
    buffer_load_dwordx4 v15, s[24:27], s80 offen offset:2048 lds
    v_mfma_f32_32x32x16_bf16 v[112:127], a[140:143], a[96:99], v[112:127]
    buffer_load_dwordx4 v16, s[24:27], s80 offen offset:3072 lds
    v_mfma_f32_32x32x16_bf16 v[128:143], a[128:131], a[112:115], v[128:143]
    s_waitcnt vmcnt(20)
    ds_read_b64_tr_b16 a[144:145], v22 offset:24576
    v_mfma_f32_32x32x16_bf16 v[144:159], a[132:135], a[112:115], v[144:159]
    ds_read_b64_tr_b16 a[146:147], v22 offset:25600
    v_mfma_f32_32x32x16_bf16 v[160:175], a[136:139], a[112:115], v[160:175]
    ds_read_b64_tr_b16 a[148:149], v23 offset:24576
    ds_read_b64_tr_b16 a[150:151], v23 offset:25600
    v_mfma_f32_32x32x16_bf16 v[176:191], a[140:143], a[112:115], v[176:191]
    ds_read_b64_tr_b16 a[152:153], v24 offset:24576
    v_mfma_f32_32x32x16_bf16 v[192:207], a[128:131], a[64:67], v[192:207]
    ds_read_b64_tr_b16 a[154:155], v24 offset:25600
    ds_read_b64_tr_b16 a[156:157], v25 offset:24576
    v_mfma_f32_32x32x16_bf16 v[208:223], a[132:135], a[64:67], v[208:223]
    ds_read_b64_tr_b16 a[158:159], v25 offset:25600
    v_mfma_f32_32x32x16_bf16 v[224:239], a[136:139], a[64:67], v[224:239]
    v_mfma_f32_32x32x16_bf16 v[240:255], a[140:143], a[64:67], v[240:255]
    s_waitcnt lgkmcnt(0)
    v_mfma_f32_32x32x16_bf16 a[160:175], a[144:147], a[84:87], a[160:175]
    s_add_u32 m0, s70, 12288
    s_add_u32 s80, s90, 196608
    buffer_load_dwordx4 v13, s[24:27], s80 offen offset:0 lds
    v_mfma_f32_32x32x16_bf16 a[176:191], a[148:151], a[84:87], a[176:191]
    buffer_load_dwordx4 v14, s[24:27], s80 offen offset:1024 lds
    v_mfma_f32_32x32x16_bf16 v[32:47], a[152:155], a[84:87], v[32:47]
    buffer_load_dwordx4 v15, s[24:27], s80 offen offset:2048 lds
    v_mfma_f32_32x32x16_bf16 v[48:63], a[156:159], a[84:87], v[48:63]
    buffer_load_dwordx4 v16, s[24:27], s80 offen offset:3072 lds
    v_mfma_f32_32x32x16_bf16 v[64:79], a[144:147], a[100:103], v[64:79]
    s_add_u32 m0, s70, 16384
    s_add_u32 s80, s78, 0
    buffer_load_dwordx4 v9, s[20:23], s80 offen offset:0 lds
    v_mfma_f32_32x32x16_bf16 v[80:95], a[148:151], a[100:103], v[80:95]
    buffer_load_dwordx4 v10, s[20:23], s80 offen offset:1024 lds
    v_mfma_f32_32x32x16_bf16 v[96:111], a[152:155], a[100:103], v[96:111]
    buffer_load_dwordx4 v11, s[20:23], s80 offen offset:2048 lds
    s_waitcnt vmcnt(11)
    ds_read_b64_tr_b16 a[128:129], v22 offset:0
    ds_read_b64_tr_b16 a[130:131], v22 offset:1024
    v_mfma_f32_32x32x16_bf16 v[112:127], a[156:159], a[100:103], v[112:127]
    buffer_load_dwordx4 v12, s[20:23], s80 offen offset:3072 lds
    ds_read_b64_tr_b16 a[132:133], v23 offset:0
    ds_read_b64_tr_b16 a[134:135], v23 offset:1024
    v_mfma_f32_32x32x16_bf16 v[128:143], a[144:147], a[116:119], v[128:143]
    ds_read_b64_tr_b16 a[136:137], v24 offset:0
    ds_read_b64_tr_b16 a[138:139], v24 offset:1024
    v_mfma_f32_32x32x16_bf16 v[144:159], a[148:151], a[116:119], v[144:159]
    ds_read_b64_tr_b16 a[140:141], v25 offset:0
    ds_read_b64_tr_b16 a[142:143], v25 offset:1024
    v_mfma_f32_32x32x16_bf16 v[160:175], a[152:155], a[116:119], v[160:175]
    ds_read_b64_tr_b16 a[192:193], v22 offset:4096
    ds_read_b64_tr_b16 a[194:195], v22 offset:5120
    v_mfma_f32_32x32x16_bf16 v[176:191], a[156:159], a[116:119], v[176:191]
    ds_read_b64_tr_b16 a[196:197], v23 offset:4096
    ds_read_b64_tr_b16 a[198:199], v23 offset:5120
    v_mfma_f32_32x32x16_bf16 v[192:207], a[144:147], a[68:71], v[192:207]
    ds_read_b64_tr_b16 a[200:201], v24 offset:4096
    ds_read_b64_tr_b16 a[202:203], v24 offset:5120
    v_mfma_f32_32x32x16_bf16 v[208:223], a[148:151], a[68:71], v[208:223]
    ds_read_b64_tr_b16 a[204:205], v25 offset:4096
    ds_read_b64_tr_b16 a[206:207], v25 offset:5120
    v_mfma_f32_32x32x16_bf16 v[224:239], a[152:155], a[68:71], v[224:239]
    v_mfma_f32_32x32x16_bf16 v[240:255], a[156:159], a[68:71], v[240:255]
    s_waitcnt vmcnt(20)
    s_barrier
    s_waitcnt lgkmcnt(0)
    v_mfma_f32_32x32x16_bf16 a[160:175], a[128:131], a[88:91], a[160:175]
    v_add_u32 v29, s41, v18
    ds_read_b128 a[0:3], v29 offset:32768
    s_add_u32 m0, s70, 24576
    s_add_u32 s80, s78, 128
    buffer_load_dwordx4 v9, s[20:23], s80 offen offset:0 lds
    v_mfma_f32_32x32x16_bf16 a[176:191], a[132:135], a[88:91], a[176:191]
    ds_read_b128 a[16:19], v29 offset:36864
    v_add_u32 v30, s41, v19
    buffer_load_dwordx4 v10, s[20:23], s80 offen offset:1024 lds
    v_mfma_f32_32x32x16_bf16 v[32:47], a[136:139], a[88:91], v[32:47]
    ds_read_b128 a[4:7], v30 offset:32768
    ds_read_b128 a[20:23], v30 offset:36864
    buffer_load_dwordx4 v11, s[20:23], s80 offen offset:2048 lds
    v_mfma_f32_32x32x16_bf16 v[48:63], a[140:143], a[88:91], v[48:63]
    v_add_u32 v29, s41, v20
    ds_read_b128 a[8:11], v29 offset:32768
    buffer_load_dwordx4 v12, s[20:23], s80 offen offset:3072 lds
    v_mfma_f32_32x32x16_bf16 a[160:175], a[192:195], a[92:95], a[160:175]
    ds_read_b128 a[24:27], v29 offset:36864
    v_add_u32 v30, s41, v21
    s_add_u32 m0, s70, 0
    s_add_u32 s80, s77, 0
    buffer_load_dwordx4 v9, s[20:23], s80 offen offset:0 lds
    v_mfma_f32_32x32x16_bf16 a[176:191], a[196:199], a[92:95], a[176:191]
    ds_read_b128 a[12:15], v30 offset:32768
    ds_read_b128 a[28:31], v30 offset:36864
    buffer_load_dwordx4 v10, s[20:23], s80 offen offset:1024 lds
    v_mfma_f32_32x32x16_bf16 v[32:47], a[200:203], a[92:95], v[32:47]
    buffer_load_dwordx4 v11, s[20:23], s80 offen offset:2048 lds
    v_mfma_f32_32x32x16_bf16 v[48:63], a[204:207], a[92:95], v[48:63]
    buffer_load_dwordx4 v12, s[20:23], s80 offen offset:3072 lds
    s_waitcnt lgkmcnt(0)
    v_mfma_f32_32x32x16_bf16 v[64:79], a[128:131], a[104:107], v[64:79]
    v_add_u32 v29, s42, v18
    ds_read_b128 a[32:35], v29 offset:32768
    s_add_u32 m0, s70, 4096
    s_add_u32 s80, s77, 128
    buffer_load_dwordx4 v9, s[20:23], s80 offen offset:0 lds
    v_mfma_f32_32x32x16_bf16 v[80:95], a[132:135], a[104:107], v[80:95]
    ds_read_b128 a[48:51], v29 offset:36864
    v_add_u32 v30, s42, v19
    v_mfma_f32_32x32x16_bf16 v[96:111], a[136:139], a[104:107], v[96:111]
    v_cvt_pk_bf16_f32 v32, v32, v33
    v_cvt_pk_bf16_f32 v33, v34, v35
    v_cvt_pk_bf16_f32 v34, v36, v37
    v_cvt_pk_bf16_f32 v35, v38, v39
    ds_read_b128 a[36:39], v30 offset:32768
    ds_read_b128 a[52:55], v30 offset:36864
    buffer_load_dwordx4 v10, s[20:23], s80 offen offset:1024 lds
    v_mfma_f32_32x32x16_bf16 v[112:127], a[140:143], a[104:107], v[112:127]
    v_cvt_pk_bf16_f32 v36, v40, v41
    v_cvt_pk_bf16_f32 v37, v42, v43
    v_cvt_pk_bf16_f32 v38, v44, v45
    v_cvt_pk_bf16_f32 v39, v46, v47
    v_add_u32 v29, s42, v20
    ds_read_b128 a[40:43], v29 offset:32768
    v_mfma_f32_32x32x16_bf16 v[64:79], a[192:195], a[108:111], v[64:79]
    v_cvt_pk_bf16_f32 v48, v48, v49
    v_cvt_pk_bf16_f32 v49, v50, v51
    v_cvt_pk_bf16_f32 v50, v52, v53
    v_cvt_pk_bf16_f32 v51, v54, v55
    ds_read_b128 a[56:59], v29 offset:36864
    v_add_u32 v30, s42, v21
    buffer_load_dwordx4 v11, s[20:23], s80 offen offset:2048 lds
    v_mfma_f32_32x32x16_bf16 v[80:95], a[196:199], a[108:111], v[80:95]
    v_cvt_pk_bf16_f32 v52, v56, v57
    v_cvt_pk_bf16_f32 v53, v58, v59
    v_cvt_pk_bf16_f32 v54, v60, v61
    v_cvt_pk_bf16_f32 v55, v62, v63
    ds_read_b128 a[44:47], v30 offset:32768
    ds_read_b128 a[60:63], v30 offset:36864
    v_mfma_f32_32x32x16_bf16 v[96:111], a[200:203], a[108:111], v[96:111]
    v_accvgpr_read_b32 v1, a160
    v_accvgpr_read_b32 v2, a161
    v_cvt_pk_bf16_f32 v40, v1, v2
    v_accvgpr_read_b32 v3, a162
    buffer_load_dwordx4 v12, s[20:23], s80 offen offset:3072 lds
    v_mfma_f32_32x32x16_bf16 v[112:127], a[204:207], a[108:111], v[112:127]
    v_accvgpr_read_b32 v4, a163
    v_cvt_pk_bf16_f32 v41, v3, v4
    v_accvgpr_read_b32 v5, a164
    v_accvgpr_read_b32 v6, a165
    s_waitcnt lgkmcnt(0)
    v_mfma_f32_32x32x16_bf16 v[128:143], a[128:131], a[120:123], v[128:143]
    v_cvt_pk_bf16_f32 v42, v5, v6
    v_accvgpr_read_b32 v7, a166
    v_accvgpr_read_b32 v8, a167
    v_cvt_pk_bf16_f32 v43, v7, v8
    v_mfma_f32_32x32x16_bf16 v[144:159], a[132:135], a[120:123], v[144:159]
    v_accvgpr_read_b32 v1, a168
    v_accvgpr_read_b32 v2, a169
    v_cvt_pk_bf16_f32 v44, v1, v2
    v_accvgpr_read_b32 v3, a170
    s_waitcnt vmcnt(44)
    ds_read_b64_tr_b16 a[144:145], v26 offset:8192
    v_mfma_f32_32x32x16_bf16 v[160:175], a[136:139], a[120:123], v[160:175]
    v_accvgpr_read_b32 v4, a171
    v_cvt_pk_bf16_f32 v45, v3, v4
    v_accvgpr_read_b32 v5, a172
    v_accvgpr_read_b32 v6, a173
    ds_read_b64_tr_b16 a[146:147], v26 offset:8704
    v_mfma_f32_32x32x16_bf16 v[176:191], a[140:143], a[120:123], v[176:191]
    v_cvt_pk_bf16_f32 v46, v5, v6
    v_accvgpr_read_b32 v7, a174
    v_accvgpr_read_b32 v8, a175
    v_cvt_pk_bf16_f32 v47, v7, v8
    ds_read_b64_tr_b16 a[148:149], v27 offset:8192
    ds_read_b64_tr_b16 a[150:151], v27 offset:8704
    v_mfma_f32_32x32x16_bf16 v[128:143], a[192:195], a[124:127], v[128:143]
    v_accvgpr_read_b32 v1, a176
    v_accvgpr_read_b32 v2, a177
    v_cvt_pk_bf16_f32 v56, v1, v2
    v_accvgpr_read_b32 v3, a178
    ds_read_b64_tr_b16 a[152:153], v26 offset:10240
    v_mfma_f32_32x32x16_bf16 v[144:159], a[196:199], a[124:127], v[144:159]
    v_accvgpr_read_b32 v4, a179
    v_cvt_pk_bf16_f32 v57, v3, v4
    v_accvgpr_read_b32 v5, a180
    v_accvgpr_read_b32 v6, a181
    ds_read_b64_tr_b16 a[154:155], v26 offset:10752
    ds_read_b64_tr_b16 a[156:157], v27 offset:10240
    v_mfma_f32_32x32x16_bf16 v[160:175], a[200:203], a[124:127], v[160:175]
    v_cvt_pk_bf16_f32 v58, v5, v6
    v_accvgpr_read_b32 v7, a182
    v_accvgpr_read_b32 v8, a183
    v_cvt_pk_bf16_f32 v59, v7, v8
    ds_read_b64_tr_b16 a[158:159], v27 offset:10752
    v_mfma_f32_32x32x16_bf16 v[176:191], a[204:207], a[124:127], v[176:191]
    v_accvgpr_read_b32 v1, a184
    v_accvgpr_read_b32 v2, a185
    v_cvt_pk_bf16_f32 v60, v1, v2
    v_accvgpr_read_b32 v3, a186
    s_waitcnt lgkmcnt(0)
    v_mfma_f32_32x32x16_bf16 v[192:207], a[128:131], a[72:75], v[192:207]
    v_accvgpr_read_b32 v4, a187
    v_cvt_pk_bf16_f32 v61, v3, v4
    v_accvgpr_read_b32 v5, a188
    v_accvgpr_read_b32 v6, a189
    s_add_u32 m0, s70, 8192
    s_add_u32 s80, s91, 0
    buffer_load_dwordx4 v13, s[24:27], s80 offen offset:0 lds
    v_mfma_f32_32x32x16_bf16 v[208:223], a[132:135], a[72:75], v[208:223]
    v_cvt_pk_bf16_f32 v62, v5, v6
    v_accvgpr_read_b32 v7, a190
    v_accvgpr_read_b32 v8, a191
    v_cvt_pk_bf16_f32 v63, v7, v8
    v_mfma_f32_32x32x16_bf16 v[224:239], a[136:139], a[72:75], v[224:239]
    v_cvt_pk_bf16_f32 v64, v64, v65
    v_cvt_pk_bf16_f32 v65, v66, v67
    v_cvt_pk_bf16_f32 v66, v68, v69
    v_cvt_pk_bf16_f32 v67, v70, v71
    s_waitcnt vmcnt(9)
    ds_read_b128 a[224:227], v18 offset:16384
    buffer_load_dwordx4 v14, s[24:27], s80 offen offset:1024 lds
    v_mfma_f32_32x32x16_bf16 v[240:255], a[140:143], a[72:75], v[240:255]
    v_cvt_pk_bf16_f32 v68, v72, v73
    v_cvt_pk_bf16_f32 v69, v74, v75
    v_cvt_pk_bf16_f32 v70, v76, v77
    v_cvt_pk_bf16_f32 v71, v78, v79
    ds_read_b128 a[228:231], v19 offset:16384
    ds_read_b128 a[232:235], v20 offset:16384
    v_mfma_f32_32x32x16_bf16 v[192:207], a[192:195], a[76:79], v[192:207]
    v_cvt_pk_bf16_f32 v80, v80, v81
    v_cvt_pk_bf16_f32 v81, v82, v83
    v_cvt_pk_bf16_f32 v82, v84, v85
    v_cvt_pk_bf16_f32 v83, v86, v87
    ds_read_b128 a[236:239], v21 offset:16384
    ds_read_b128 a[240:243], v18 offset:24576
    buffer_load_dwordx4 v15, s[24:27], s80 offen offset:2048 lds
    v_mfma_f32_32x32x16_bf16 v[208:223], a[196:199], a[76:79], v[208:223]
    v_cvt_pk_bf16_f32 v84, v88, v89
    v_cvt_pk_bf16_f32 v85, v90, v91
    v_cvt_pk_bf16_f32 v86, v92, v93
    v_cvt_pk_bf16_f32 v87, v94, v95
    ds_read_b128 a[244:247], v19 offset:24576
    ds_read_b128 a[248:251], v20 offset:24576
    v_mfma_f32_32x32x16_bf16 v[224:239], a[200:203], a[76:79], v[224:239]
    v_cvt_pk_bf16_f32 v96, v96, v97
    v_cvt_pk_bf16_f32 v97, v98, v99
    v_cvt_pk_bf16_f32 v98, v100, v101
    v_cvt_pk_bf16_f32 v99, v102, v103
    ds_read_b128 a[252:255], v21 offset:24576
    buffer_load_dwordx4 v16, s[24:27], s80 offen offset:3072 lds
    v_mfma_f32_32x32x16_bf16 v[240:255], a[204:207], a[76:79], v[240:255]
    v_cvt_pk_bf16_f32 v100, v104, v105
    v_cvt_pk_bf16_f32 v101, v106, v107
    v_cvt_pk_bf16_f32 v102, v108, v109
    v_cvt_pk_bf16_f32 v103, v110, v111
    s_waitcnt lgkmcnt(0)
    v_mfma_f32_32x32x16_bf16 a[64:79], a[0:3], v[40:43], 0
    v_cvt_pk_bf16_f32 v112, v112, v113
    v_cvt_pk_bf16_f32 v113, v114, v115
    v_cvt_pk_bf16_f32 v114, v116, v117
    v_cvt_pk_bf16_f32 v115, v118, v119
    v_mfma_f32_32x32x16_bf16 a[64:79], a[4:7], v[44:47], a[64:79]
    v_cvt_pk_bf16_f32 v116, v120, v121
    v_cvt_pk_bf16_f32 v117, v122, v123
    v_cvt_pk_bf16_f32 v118, v124, v125
    v_cvt_pk_bf16_f32 v119, v126, v127
    s_waitcnt vmcnt(63)
    ds_read_b64_tr_b16 a[128:129], v26 offset:20480
    v_mfma_f32_32x32x16_bf16 a[64:79], a[8:11], v[56:59], a[64:79]
    v_cvt_pk_bf16_f32 v128, v128, v129
    v_cvt_pk_bf16_f32 v129, v130, v131
    v_cvt_pk_bf16_f32 v130, v132, v133
    v_cvt_pk_bf16_f32 v131, v134, v135
    ds_read_b64_tr_b16 a[130:131], v26 offset:20992
    v_mfma_f32_32x32x16_bf16 a[64:79], a[12:15], v[60:63], a[64:79]
    v_cvt_pk_bf16_f32 v132, v136, v137
    v_cvt_pk_bf16_f32 v133, v138, v139
    v_cvt_pk_bf16_f32 v134, v140, v141
    v_cvt_pk_bf16_f32 v135, v142, v143
    ds_read_b64_tr_b16 a[132:133], v27 offset:20480
    ds_read_b64_tr_b16 a[134:135], v27 offset:20992
    v_mfma_f32_32x32x16_bf16 a[64:79], a[16:19], v[32:35], a[64:79]
    v_cvt_pk_bf16_f32 v144, v144, v145
    v_cvt_pk_bf16_f32 v145, v146, v147
    v_cvt_pk_bf16_f32 v146, v148, v149
    v_cvt_pk_bf16_f32 v147, v150, v151
    ds_read_b64_tr_b16 a[136:137], v26 offset:22528
    v_mfma_f32_32x32x16_bf16 a[64:79], a[20:23], v[36:39], a[64:79]
    v_cvt_pk_bf16_f32 v148, v152, v153
    v_cvt_pk_bf16_f32 v149, v154, v155
    v_cvt_pk_bf16_f32 v150, v156, v157
    v_cvt_pk_bf16_f32 v151, v158, v159
    ds_read_b64_tr_b16 a[138:139], v26 offset:23040
    ds_read_b64_tr_b16 a[140:141], v27 offset:22528
    v_mfma_f32_32x32x16_bf16 a[64:79], a[24:27], v[48:51], a[64:79]
    v_cvt_pk_bf16_f32 v160, v160, v161
    v_cvt_pk_bf16_f32 v161, v162, v163
    v_cvt_pk_bf16_f32 v162, v164, v165
    v_cvt_pk_bf16_f32 v163, v166, v167
    ds_read_b64_tr_b16 a[142:143], v27 offset:23040
    v_mfma_f32_32x32x16_bf16 a[64:79], a[28:31], v[52:55], a[64:79]
    v_cvt_pk_bf16_f32 v164, v168, v169
    v_cvt_pk_bf16_f32 v165, v170, v171
    v_cvt_pk_bf16_f32 v166, v172, v173
    v_cvt_pk_bf16_f32 v167, v174, v175
    s_waitcnt lgkmcnt(0)
    v_mfma_f32_32x32x16_bf16 a[80:95], a[32:35], v[64:67], 0
    v_cvt_pk_bf16_f32 v176, v176, v177
    v_cvt_pk_bf16_f32 v177, v178, v179
    v_cvt_pk_bf16_f32 v178, v180, v181
    v_add_u32 v29, s43, v18
    ds_read_b128 a[0:3], v29 offset:32768
    v_mfma_f32_32x32x16_bf16 a[80:95], a[36:39], v[68:71], a[80:95]
    v_cvt_pk_bf16_f32 v179, v182, v183
    v_cvt_pk_bf16_f32 v180, v184, v185
    ds_read_b128 a[16:19], v29 offset:36864
    v_add_u32 v30, s43, v19
    v_mfma_f32_32x32x16_bf16 a[80:95], a[40:43], v[80:83], a[80:95]
    v_cvt_pk_bf16_f32 v181, v186, v187
    v_cvt_pk_bf16_f32 v182, v188, v189
    v_cvt_pk_bf16_f32 v183, v190, v191
    ds_read_b128 a[4:7], v30 offset:32768
    ds_read_b128 a[20:23], v30 offset:36864
    v_mfma_f32_32x32x16_bf16 a[80:95], a[44:47], v[84:87], a[80:95]
    v_cvt_pk_bf16_f32 v192, v192, v193
    v_cvt_pk_bf16_f32 v193, v194, v195
    v_add_u32 v29, s43, v20
    ds_read_b128 a[8:11], v29 offset:32768
    ds_write_b128 v28, a[64:67] offset:16384
    v_mfma_f32_32x32x16_bf16 a[80:95], a[48:51], v[96:99], a[80:95]
    v_cvt_pk_bf16_f32 v194, v196, v197
    v_cvt_pk_bf16_f32 v195, v198, v199
    v_cvt_pk_bf16_f32 v196, v200, v201
    ds_read_b128 a[24:27], v29 offset:36864
    v_add_u32 v30, s43, v21
    ds_write_b128 v28, a[68:71] offset:17408
    v_mfma_f32_32x32x16_bf16 a[80:95], a[52:55], v[100:103], a[80:95]
    v_cvt_pk_bf16_f32 v197, v202, v203
    v_cvt_pk_bf16_f32 v198, v204, v205
    ds_read_b128 a[12:15], v30 offset:32768
    ds_read_b128 a[28:31], v30 offset:36864
    ds_write_b128 v28, a[72:75] offset:18432
    v_mfma_f32_32x32x16_bf16 a[80:95], a[56:59], v[112:115], a[80:95]
    v_cvt_pk_bf16_f32 v199, v206, v207
    v_cvt_pk_bf16_f32 v208, v208, v209
    v_cvt_pk_bf16_f32 v209, v210, v211
    ds_write_b128 v28, a[76:79] offset:19456
    v_mfma_f32_32x32x16_bf16 a[80:95], a[60:63], v[116:119], a[80:95]
    v_cvt_pk_bf16_f32 v210, v212, v213
    v_cvt_pk_bf16_f32 v211, v214, v215
    s_waitcnt lgkmcnt(0)
    v_mfma_f32_32x32x16_bf16 a[96:111], a[0:3], v[128:131], 0
    v_cvt_pk_bf16_f32 v212, v216, v217
    v_cvt_pk_bf16_f32 v213, v218, v219
    v_cvt_pk_bf16_f32 v214, v220, v221
    ds_read_b128 a[32:35], v18 offset:32768
    ds_read_b128 a[48:51], v18 offset:36864
    v_mfma_f32_32x32x16_bf16 a[96:111], a[4:7], v[132:135], a[96:111]
    v_cvt_pk_bf16_f32 v215, v222, v223
    v_cvt_pk_bf16_f32 v224, v224, v225
    ds_read_b128 a[36:39], v19 offset:32768
    v_mfma_f32_32x32x16_bf16 a[96:111], a[8:11], v[144:147], a[96:111]
    v_cvt_pk_bf16_f32 v225, v226, v227
    v_cvt_pk_bf16_f32 v226, v228, v229
    v_cvt_pk_bf16_f32 v227, v230, v231
    ds_read_b128 a[52:55], v19 offset:36864
    v_mfma_f32_32x32x16_bf16 a[96:111], a[12:15], v[148:151], a[96:111]
    v_cvt_pk_bf16_f32 v228, v232, v233
    v_cvt_pk_bf16_f32 v229, v234, v235
    ds_read_b128 a[40:43], v20 offset:32768
    ds_read_b128 a[56:59], v20 offset:36864
    ds_write_b128 v28, a[80:83] offset:24576
    v_mfma_f32_32x32x16_bf16 a[96:111], a[16:19], v[160:163], a[96:111]
    v_cvt_pk_bf16_f32 v230, v236, v237
    v_cvt_pk_bf16_f32 v231, v238, v239
    v_cvt_pk_bf16_f32 v240, v240, v241
    ds_read_b128 a[44:47], v21 offset:32768
    ds_write_b128 v28, a[84:87] offset:25600
    v_mfma_f32_32x32x16_bf16 a[96:111], a[20:23], v[164:167], a[96:111]
    v_cvt_pk_bf16_f32 v241, v242, v243
    v_cvt_pk_bf16_f32 v242, v244, v245
    ds_read_b128 a[60:63], v21 offset:36864
    ds_write_b128 v28, a[88:91] offset:26624
    v_mfma_f32_32x32x16_bf16 a[96:111], a[24:27], v[176:179], a[96:111]
    v_cvt_pk_bf16_f32 v243, v246, v247
    v_cvt_pk_bf16_f32 v244, v248, v249
    v_cvt_pk_bf16_f32 v245, v250, v251
    ds_write_b128 v28, a[92:95] offset:27648
    v_mfma_f32_32x32x16_bf16 a[96:111], a[28:31], v[180:183], a[96:111]
    v_cvt_pk_bf16_f32 v246, v252, v253
    v_cvt_pk_bf16_f32 v247, v254, v255
    s_waitcnt lgkmcnt(0)
    v_mfma_f32_32x32x16_bf16 v[64:79], a[32:35], v[192:195], 0
    v_mfma_f32_32x32x16_bf16 v[64:79], a[36:39], v[196:199], v[64:79]
    v_mfma_f32_32x32x16_bf16 v[64:79], a[40:43], v[208:211], v[64:79]
    s_waitcnt vmcnt(4)
    ds_read_b128 a[192:195], v18 offset:0
    v_mfma_f32_32x32x16_bf16 v[64:79], a[44:47], v[212:215], v[64:79]
    s_nop 2
    ds_write_b128 v28, a[96:99] offset:20480
    ds_read_b128 a[196:199], v19 offset:0
    ds_read_b128 a[200:203], v20 offset:0
    v_mfma_f32_32x32x16_bf16 v[64:79], a[48:51], v[224:227], v[64:79]
    ds_write_b128 v28, a[100:103] offset:21504
    ds_read_b128 a[204:207], v21 offset:0
    ds_read_b128 a[208:211], v18 offset:4096
    v_mfma_f32_32x32x16_bf16 v[64:79], a[52:55], v[228:231], v[64:79]
    ds_write_b128 v28, a[104:107] offset:22528
    ds_read_b128 a[212:215], v19 offset:4096
    ds_read_b128 a[216:219], v20 offset:4096
    v_mfma_f32_32x32x16_bf16 v[64:79], a[56:59], v[240:243], v[64:79]
    ds_write_b128 v28, a[108:111] offset:23552
    ds_read_b128 a[220:223], v21 offset:4096
    v_mfma_f32_32x32x16_bf16 v[64:79], a[60:63], v[244:247], v[64:79]
    s_waitcnt lgkmcnt(0)
    s_barrier
    s_waitcnt lgkmcnt(0)
    v_mfma_f32_32x32x16_bf16 v[96:111], a[192:195], a[128:131], 0
    v_add_u32 v1, s41, v28
    ds_read_b128 v[208:211], v1 offset:16384
    ds_read_b128 v[212:215], v1 offset:17408
    ds_read_b128 v[216:219], v1 offset:18432
    ds_read_b128 v[220:223], v1 offset:19456
    s_add_u32 m0, s70, 32768
    s_add_u32 s80, s91, 65536
    buffer_load_dwordx4 v13, s[24:27], s80 offen offset:0 lds
    buffer_load_dwordx4 v14, s[24:27], s80 offen offset:1024 lds
    v_mfma_f32_32x32x16_bf16 v[112:127], a[192:195], a[132:135], 0
    v_add_u32 v2, s42, v28
    ds_read_b128 v[224:227], v2 offset:24576
    ds_read_b128 v[228:231], v2 offset:25600
    ds_read_b128 v[232:235], v2 offset:26624
    ds_read_b128 v[236:239], v2 offset:27648
    buffer_load_dwordx4 v15, s[24:27], s80 offen offset:2048 lds
    v_mfma_f32_32x32x16_bf16 v[128:143], a[224:227], a[128:131], 0
    v_add_u32 v3, s43, v28
    ds_read_b128 v[240:243], v3 offset:20480
    ds_read_b128 v[244:247], v3 offset:21504
    ds_read_b128 v[248:251], v3 offset:22528
    ds_read_b128 v[252:255], v3 offset:23552
    buffer_load_dwordx4 v16, s[24:27], s80 offen offset:3072 lds
    s_add_u32 m0, s70, 36864
    s_add_u32 s80, s91, 131072
    buffer_load_dwordx4 v13, s[24:27], s80 offen offset:0 lds
    v_mfma_f32_32x32x16_bf16 v[144:159], a[224:227], a[132:135], 0
    buffer_load_dwordx4 v14, s[24:27], s80 offen offset:1024 lds
    v_mfma_f32_32x32x16_bf16 v[96:111], a[196:199], a[136:139], v[96:111]
    buffer_load_dwordx4 v15, s[24:27], s80 offen offset:2048 lds
    buffer_load_dwordx4 v16, s[24:27], s80 offen offset:3072 lds
    v_mfma_f32_32x32x16_bf16 v[112:127], a[196:199], a[140:143], v[112:127]
    s_add_u32 m0, s70, 0
    s_add_u32 s80, s91, 196608
    buffer_load_dwordx4 v13, s[24:27], s80 offen offset:0 lds
    s_waitcnt lgkmcnt(0)
    v_add_f32 v208, v208, v224
    v_add_f32 v209, v209, v225
    v_add_f32 v210, v210, v226
    v_add_f32 v211, v211, v227
    v_mfma_f32_32x32x16_bf16 v[128:143], a[228:231], a[136:139], v[128:143]
    buffer_load_dwordx4 v14, s[24:27], s80 offen offset:1024 lds
    buffer_load_dwordx4 v15, s[24:27], s80 offen offset:2048 lds
    v_add_f32 v212, v212, v228
    v_add_f32 v213, v213, v229
    v_add_f32 v214, v214, v230
    v_add_f32 v215, v215, v231
    v_mfma_f32_32x32x16_bf16 v[144:159], a[228:231], a[140:143], v[144:159]
    buffer_load_dwordx4 v16, s[24:27], s80 offen offset:3072 lds
    s_waitcnt vmcnt(32)
    ds_read_b64_tr_b16 a[160:161], v26 offset:28672
    ds_read_b64_tr_b16 a[162:163], v26 offset:29184
    v_add_f32 v216, v216, v232
    v_add_f32 v217, v217, v233
    v_add_f32 v218, v218, v234
    v_add_f32 v219, v219, v235
    v_mfma_f32_32x32x16_bf16 v[96:111], a[200:203], a[144:147], v[96:111]
    ds_read_b64_tr_b16 a[164:165], v27 offset:28672
    ds_read_b64_tr_b16 a[166:167], v27 offset:29184
    v_add_f32 v220, v220, v236
    v_add_f32 v221, v221, v237
    v_add_f32 v222, v222, v238
    v_add_f32 v223, v223, v239
    v_mfma_f32_32x32x16_bf16 v[112:127], a[200:203], a[148:151], v[112:127]
    ds_read_b64_tr_b16 a[168:169], v26 offset:30720
    ds_read_b64_tr_b16 a[170:171], v26 offset:31232
    ds_read_b64_tr_b16 a[172:173], v27 offset:30720
    v_add_f32 v64, v64, v240
    v_add_f32 v65, v65, v241
    v_add_f32 v66, v66, v242
    v_add_f32 v67, v67, v243
    v_mfma_f32_32x32x16_bf16 v[128:143], a[232:235], a[144:147], v[128:143]
    ds_read_b64_tr_b16 a[174:175], v27 offset:31232
    ds_read_b64_tr_b16 a[176:177], v26 offset:12288
    v_add_f32 v68, v68, v244
    v_add_f32 v69, v69, v245
    v_add_f32 v70, v70, v246
    v_add_f32 v71, v71, v247
    v_add_f32 v72, v72, v248
    v_mfma_f32_32x32x16_bf16 v[144:159], a[232:235], a[148:151], v[144:159]
    ds_read_b64_tr_b16 a[178:179], v26 offset:12800
    ds_read_b64_tr_b16 a[180:181], v27 offset:12288
    ds_read_b64_tr_b16 a[182:183], v27 offset:12800
    v_add_f32 v73, v73, v249
    v_add_f32 v74, v74, v250
    v_add_f32 v75, v75, v251
    v_add_f32 v76, v76, v252
    v_mfma_f32_32x32x16_bf16 v[96:111], a[204:207], a[152:155], v[96:111]
    ds_read_b64_tr_b16 a[184:185], v26 offset:14336
    ds_read_b64_tr_b16 a[186:187], v26 offset:14848
    v_add_f32 v77, v77, v253
    v_add_f32 v78, v78, v254
    v_add_f32 v79, v79, v255
    v_add_f32 v64, v64, v208
    v_mfma_f32_32x32x16_bf16 v[112:127], a[204:207], a[156:159], v[112:127]
    ds_read_b64_tr_b16 a[188:189], v27 offset:14336
    ds_read_b64_tr_b16 a[190:191], v27 offset:14848
    v_add_f32 v65, v65, v209
    v_add_f32 v66, v66, v210
    v_add_f32 v67, v67, v211
    v_add_f32 v68, v68, v212
    v_mfma_f32_32x32x16_bf16 v[128:143], a[236:239], a[152:155], v[128:143]
    v_add_f32 v69, v69, v213
    v_add_f32 v70, v70, v214
    v_add_f32 v71, v71, v215
    v_add_f32 v72, v72, v216
    v_mfma_f32_32x32x16_bf16 v[144:159], a[236:239], a[156:159], v[144:159]
    v_add_f32 v73, v73, v217
    v_add_f32 v74, v74, v218
    v_add_f32 v75, v75, v219
    v_add_f32 v76, v76, v220
    s_waitcnt lgkmcnt(0)
    v_mfma_f32_32x32x16_bf16 v[96:111], a[208:211], a[160:163], v[96:111]
    s_add_u32 m0, s70, 4096
    s_add_u32 s80, s92, 0
    buffer_load_dwordx4 v13, s[24:27], s80 offen offset:0 lds
    buffer_load_dwordx4 v14, s[24:27], s80 offen offset:1024 lds
    v_add_f32 v77, v77, v221
    v_add_f32 v78, v78, v222
    v_add_f32 v79, v79, v223
    v_mfma_f32_32x32x16_bf16 v[112:127], a[208:211], a[164:167], v[112:127]
    buffer_load_dwordx4 v15, s[24:27], s80 offen offset:2048 lds
    v_max3_f32 v1, v64, v65, v66
    v_max3_f32 v2, v67, v68, v69
    v_max3_f32 v1, v1, v70, v71
    v_mfma_f32_32x32x16_bf16 v[128:143], a[240:243], a[160:163], v[128:143]
    buffer_load_dwordx4 v16, s[24:27], s80 offen offset:3072 lds
    s_add_u32 m0, s70, 28672
    s_add_u32 s80, s92, 65536
    buffer_load_dwordx4 v13, s[24:27], s80 offen offset:0 lds
    v_max3_f32 v2, v2, v72, v73
    v_max3_f32 v1, v1, v74, v75
    v_max3_f32 v2, v2, v76, v77
    v_mfma_f32_32x32x16_bf16 v[144:159], a[240:243], a[164:167], v[144:159]
    buffer_load_dwordx4 v14, s[24:27], s80 offen offset:1024 lds
    v_max3_f32 v1, v1, v78, v79
    v_max_f32 v1, v1, v2
    v_mov_b32 v2, v1
    v_mfma_f32_32x32x16_bf16 v[96:111], a[212:215], a[168:171], v[96:111]
    buffer_load_dwordx4 v15, s[24:27], s80 offen offset:2048 lds
    buffer_load_dwordx4 v16, s[24:27], s80 offen offset:3072 lds
    v_permlane32_swap_b32 v1, v2
    v_max_f32 v1, v1, v2
    v_mul_f32 v1, s48, v1
    v_mfma_f32_32x32x16_bf16 v[112:127], a[212:215], a[172:175], v[112:127]
    s_add_u32 m0, s70, 12288
    s_add_u32 s80, s92, 131072
    buffer_load_dwordx4 v13, s[24:27], s80 offen offset:0 lds
    v_fma_f32 v64, v64, s48, -v1
    v_fma_f32 v65, v65, s48, -v1
    v_fma_f32 v66, v66, s48, -v1
    v_mfma_f32_32x32x16_bf16 v[128:143], a[244:247], a[168:171], v[128:143]
    buffer_load_dwordx4 v14, s[24:27], s80 offen offset:1024 lds
    buffer_load_dwordx4 v15, s[24:27], s80 offen offset:2048 lds
    v_fma_f32 v67, v67, s48, -v1
    v_fma_f32 v68, v68, s48, -v1
    v_fma_f32 v69, v69, s48, -v1
    v_mfma_f32_32x32x16_bf16 v[144:159], a[244:247], a[172:175], v[144:159]
    buffer_load_dwordx4 v16, s[24:27], s80 offen offset:3072 lds
    s_waitcnt vmcnt(20)
    ds_read_b64_tr_b16 a[128:129], v26 offset:8192
    ds_read_b64_tr_b16 a[130:131], v26 offset:8704
    v_fma_f32 v70, v70, s48, -v1
    v_fma_f32 v71, v71, s48, -v1
    v_mfma_f32_32x32x16_bf16 v[96:111], a[216:219], a[176:179], v[96:111]
    ds_read_b64_tr_b16 a[132:133], v27 offset:8192
    ds_read_b64_tr_b16 a[134:135], v27 offset:8704
    v_fma_f32 v72, v72, s48, -v1
    v_fma_f32 v73, v73, s48, -v1
    v_fma_f32 v74, v74, s48, -v1
    v_mfma_f32_32x32x16_bf16 v[112:127], a[216:219], a[180:183], v[112:127]
    ds_read_b64_tr_b16 a[136:137], v26 offset:10240
    ds_read_b64_tr_b16 a[138:139], v26 offset:10752
    ds_read_b64_tr_b16 a[140:141], v27 offset:10240
    v_fma_f32 v75, v75, s48, -v1
    v_fma_f32 v76, v76, s48, -v1
    v_fma_f32 v77, v77, s48, -v1
    v_mfma_f32_32x32x16_bf16 v[128:143], a[248:251], a[176:179], v[128:143]
    ds_read_b64_tr_b16 a[142:143], v27 offset:10752
    ds_read_b64_tr_b16 a[144:145], v26 offset:32768
    v_fma_f32 v78, v78, s48, -v1
    v_fma_f32 v79, v79, s48, -v1
    v_exp_f32 v64, v64
    v_mfma_f32_32x32x16_bf16 v[144:159], a[248:251], a[180:183], v[144:159]
    ds_read_b64_tr_b16 a[146:147], v26 offset:33280
    ds_read_b64_tr_b16 a[148:149], v27 offset:32768
    ds_read_b64_tr_b16 a[150:151], v27 offset:33280
    v_exp_f32 v65, v65
    v_exp_f32 v66, v66
    v_exp_f32 v67, v67
    v_mfma_f32_32x32x16_bf16 v[96:111], a[220:223], a[184:187], v[96:111]
    ds_read_b64_tr_b16 a[152:153], v26 offset:34816
    ds_read_b64_tr_b16 a[154:155], v26 offset:35328
    v_exp_f32 v68, v68
    v_exp_f32 v69, v69
    v_exp_f32 v70, v70
    v_mfma_f32_32x32x16_bf16 v[112:127], a[220:223], a[188:191], v[112:127]
    ds_read_b64_tr_b16 a[156:157], v27 offset:34816
    ds_read_b64_tr_b16 a[158:159], v27 offset:35328
    v_exp_f32 v71, v71
    v_exp_f32 v72, v72
    v_exp_f32 v73, v73
    v_mfma_f32_32x32x16_bf16 v[128:143], a[252:255], a[184:187], v[128:143]
    v_exp_f32 v74, v74
    v_exp_f32 v75, v75
    v_exp_f32 v76, v76
    v_mfma_f32_32x32x16_bf16 v[144:159], a[252:255], a[188:191], v[144:159]
    v_exp_f32 v77, v77
    v_exp_f32 v78, v78
    s_waitcnt lgkmcnt(0)
    v_mfma_f32_32x32x16_bf16 v[160:175], a[192:195], a[128:131], 0
    s_add_u32 m0, s70, 8192
    s_add_u32 s80, s92, 196608
    buffer_load_dwordx4 v13, s[24:27], s80 offen offset:0 lds
    v_exp_f32 v79, v79
    v_add_f32 v1, v64, v65
    v_add_f32 v2, v66, v67
    v_mfma_f32_32x32x16_bf16 v[176:191], a[192:195], a[132:135], 0
    buffer_load_dwordx4 v14, s[24:27], s80 offen offset:1024 lds
    v_add_f32 v1, v1, v68
    v_add_f32 v2, v2, v69
    v_add_f32 v1, v1, v70
    v_mfma_f32_32x32x16_bf16 v[32:47], a[224:227], a[128:131], 0
    buffer_load_dwordx4 v15, s[24:27], s80 offen offset:2048 lds
    v_add_f32 v2, v2, v71
    v_add_f32 v1, v1, v72
    v_add_f32 v2, v2, v73
    v_mfma_f32_32x32x16_bf16 v[48:63], a[224:227], a[132:135], 0
    buffer_load_dwordx4 v16, s[24:27], s80 offen offset:3072 lds
    v_add_f32 v1, v1, v74
    v_add_f32 v2, v2, v75
    v_add_f32 v1, v1, v76
    v_mfma_f32_32x32x16_bf16 v[160:175], a[196:199], a[136:139], v[160:175]
    s_add_u32 m0, s70, 32768
    s_add_u32 s80, s93, 0
    buffer_load_dwordx4 v13, s[24:27], s80 offen offset:0 lds
    v_add_f32 v2, v2, v77
    v_add_f32 v1, v1, v78
    v_add_f32 v2, v2, v79
    v_mfma_f32_32x32x16_bf16 v[176:191], a[196:199], a[140:143], v[176:191]
    buffer_load_dwordx4 v14, s[24:27], s80 offen offset:1024 lds
    v_add_f32 v1, v1, v2
    v_mov_b32 v2, v1
    s_nop 1
    v_permlane32_swap_b32 v1, v2
    v_mfma_f32_32x32x16_bf16 v[32:47], a[228:231], a[136:139], v[32:47]
    buffer_load_dwordx4 v15, s[24:27], s80 offen offset:2048 lds
    v_add_f32 v1, v1, v2
    v_rcp_f32 v1, v1
    v_lshlrev_b32 v3, 4, v0
    v_mfma_f32_32x32x16_bf16 v[48:63], a[228:231], a[140:143], v[48:63]
    buffer_load_dwordx4 v16, s[24:27], s80 offen offset:3072 lds
    s_waitcnt vmcnt(20)
    ds_read_b64_tr_b16 a[160:161], v26 offset:36864
    ds_read_b64_tr_b16 a[162:163], v26 offset:37376
    v_mul_f32 v64, v64, v1
    v_mul_f32 v65, v65, v1
    v_mul_f32 v66, v66, v1
    v_mfma_f32_32x32x16_bf16 v[160:175], a[200:203], a[144:147], v[160:175]
    ds_read_b64_tr_b16 a[164:165], v27 offset:36864
    ds_read_b64_tr_b16 a[166:167], v27 offset:37376
    v_mul_f32 v67, v67, v1
    v_mul_f32 v68, v68, v1
    v_mul_f32 v69, v69, v1
    v_mfma_f32_32x32x16_bf16 v[176:191], a[200:203], a[148:151], v[176:191]
    ds_read_b64_tr_b16 a[168:169], v26 offset:38912
    ds_read_b64_tr_b16 a[170:171], v26 offset:39424
    ds_read_b64_tr_b16 a[172:173], v27 offset:38912
    v_mul_f32 v70, v70, v1
    v_mul_f32 v71, v71, v1
    v_mul_f32 v72, v72, v1
    v_mfma_f32_32x32x16_bf16 v[32:47], a[232:235], a[144:147], v[32:47]
    ds_read_b64_tr_b16 a[174:175], v27 offset:39424
    ds_read_b64_tr_b16 a[176:177], v26 offset:0
    v_mul_f32 v73, v73, v1
    v_mul_f32 v74, v74, v1
    v_mul_f32 v75, v75, v1
    v_mfma_f32_32x32x16_bf16 v[48:63], a[232:235], a[148:151], v[48:63]
    ds_read_b64_tr_b16 a[178:179], v26 offset:512
    ds_read_b64_tr_b16 a[180:181], v27 offset:0
    ds_read_b64_tr_b16 a[182:183], v27 offset:512
    v_mul_f32 v76, v76, v1
    v_mul_f32 v77, v77, v1
    v_mul_f32 v78, v78, v1
    v_mfma_f32_32x32x16_bf16 v[160:175], a[204:207], a[152:155], v[160:175]
    ds_read_b64_tr_b16 a[184:185], v26 offset:2048
    ds_read_b64_tr_b16 a[186:187], v26 offset:2560
    v_mul_f32 v79, v79, v1
    v_cvt_pk_bf16_f32 v64, v64, v65
    v_cvt_pk_bf16_f32 v65, v66, v67
    v_mfma_f32_32x32x16_bf16 v[176:191], a[204:207], a[156:159], v[176:191]
    ds_read_b64_tr_b16 a[188:189], v27 offset:2048
    ds_read_b64_tr_b16 a[190:191], v27 offset:2560
    v_cvt_pk_bf16_f32 v66, v68, v69
    v_cvt_pk_bf16_f32 v67, v70, v71
    v_cvt_pk_bf16_f32 v68, v72, v73
    v_mfma_f32_32x32x16_bf16 v[32:47], a[236:239], a[152:155], v[32:47]
    v_cvt_pk_bf16_f32 v69, v74, v75
    v_cvt_pk_bf16_f32 v70, v76, v77
    v_cvt_pk_bf16_f32 v71, v78, v79
    v_mfma_f32_32x32x16_bf16 v[48:63], a[236:239], a[156:159], v[48:63]
    buffer_store_dwordx4 v[64:67], v3, s[28:31], s46 offen offset:0 sc1
    buffer_store_dwordx4 v[68:71], v3, s[28:31], s46 offen offset:1024 sc1
    s_waitcnt lgkmcnt(0)
    v_mfma_f32_32x32x16_bf16 v[160:175], a[208:211], a[160:163], v[160:175]
    s_add_u32 m0, s70, 36864
    s_add_u32 s80, s93, 65536
    buffer_load_dwordx4 v13, s[24:27], s80 offen offset:0 lds
    v_cvt_pk_bf16_f32 v96, v96, v97
    v_accvgpr_write_b32 a64, v96
    v_cvt_pk_bf16_f32 v97, v98, v99
    v_mfma_f32_32x32x16_bf16 v[176:191], a[208:211], a[164:167], v[176:191]
    buffer_load_dwordx4 v14, s[24:27], s80 offen offset:1024 lds
    v_accvgpr_write_b32 a65, v97
    v_cvt_pk_bf16_f32 v98, v100, v101
    v_mfma_f32_32x32x16_bf16 v[32:47], a[240:243], a[160:163], v[32:47]
    buffer_load_dwordx4 v15, s[24:27], s80 offen offset:2048 lds
    v_accvgpr_write_b32 a66, v98
    v_cvt_pk_bf16_f32 v99, v102, v103
    v_accvgpr_write_b32 a67, v99
    v_mfma_f32_32x32x16_bf16 v[48:63], a[240:243], a[164:167], v[48:63]
    buffer_load_dwordx4 v16, s[24:27], s80 offen offset:3072 lds
    v_cvt_pk_bf16_f32 v100, v104, v105
    v_accvgpr_write_b32 a68, v100
    v_mfma_f32_32x32x16_bf16 v[160:175], a[212:215], a[168:171], v[160:175]
    s_add_u32 m0, s70, 0
    s_add_u32 s80, s93, 131072
    buffer_load_dwordx4 v13, s[24:27], s80 offen offset:0 lds
    v_cvt_pk_bf16_f32 v101, v106, v107
    v_accvgpr_write_b32 a69, v101
    v_cvt_pk_bf16_f32 v102, v108, v109
    v_mfma_f32_32x32x16_bf16 v[176:191], a[212:215], a[172:175], v[176:191]
    buffer_load_dwordx4 v14, s[24:27], s80 offen offset:1024 lds
    v_accvgpr_write_b32 a70, v102
    v_cvt_pk_bf16_f32 v103, v110, v111
    v_mfma_f32_32x32x16_bf16 v[32:47], a[244:247], a[168:171], v[32:47]
    buffer_load_dwordx4 v15, s[24:27], s80 offen offset:2048 lds
    v_accvgpr_write_b32 a71, v103
    v_cvt_pk_bf16_f32 v104, v112, v113
    v_accvgpr_write_b32 a72, v104
    v_mfma_f32_32x32x16_bf16 v[48:63], a[244:247], a[172:175], v[48:63]
    buffer_load_dwordx4 v16, s[24:27], s80 offen offset:3072 lds
    s_waitcnt vmcnt(22)
    ds_read_b64_tr_b16 a[128:129], v26 offset:4096
    ds_read_b64_tr_b16 a[130:131], v26 offset:4608
    v_cvt_pk_bf16_f32 v105, v114, v115
    v_accvgpr_write_b32 a73, v105
    v_mfma_f32_32x32x16_bf16 v[160:175], a[216:219], a[176:179], v[160:175]
    ds_read_b64_tr_b16 a[132:133], v27 offset:4096
    ds_read_b64_tr_b16 a[134:135], v27 offset:4608
    v_cvt_pk_bf16_f32 v106, v116, v117
    v_accvgpr_write_b32 a74, v106
    v_cvt_pk_bf16_f32 v107, v118, v119
    v_mfma_f32_32x32x16_bf16 v[176:191], a[216:219], a[180:183], v[176:191]
    ds_read_b64_tr_b16 a[136:137], v26 offset:6144
    ds_read_b64_tr_b16 a[138:139], v26 offset:6656
    ds_read_b64_tr_b16 a[140:141], v27 offset:6144
    v_accvgpr_write_b32 a75, v107
    v_cvt_pk_bf16_f32 v108, v120, v121
    v_mfma_f32_32x32x16_bf16 v[32:47], a[248:251], a[176:179], v[32:47]
    ds_read_b64_tr_b16 a[142:143], v27 offset:6656
    ds_read_b64_tr_b16 a[144:145], v26 offset:28672
    v_accvgpr_write_b32 a76, v108
    v_cvt_pk_bf16_f32 v109, v122, v123
    v_accvgpr_write_b32 a77, v109
    v_mfma_f32_32x32x16_bf16 v[48:63], a[248:251], a[180:183], v[48:63]
    ds_read_b64_tr_b16 a[146:147], v26 offset:29184
    ds_read_b64_tr_b16 a[148:149], v27 offset:28672
    ds_read_b64_tr_b16 a[150:151], v27 offset:29184
    v_cvt_pk_bf16_f32 v110, v124, v125
    v_accvgpr_write_b32 a78, v110
    v_mfma_f32_32x32x16_bf16 v[160:175], a[220:223], a[184:187], v[160:175]
    ds_read_b64_tr_b16 a[152:153], v26 offset:30720
    ds_read_b64_tr_b16 a[154:155], v26 offset:31232
    v_cvt_pk_bf16_f32 v111, v126, v127
    v_accvgpr_write_b32 a79, v111
    v_cvt_pk_bf16_f32 v112, v128, v129
    v_mfma_f32_32x32x16_bf16 v[176:191], a[220:223], a[188:191], v[176:191]
    ds_read_b64_tr_b16 a[156:157], v27 offset:30720
    ds_read_b64_tr_b16 a[158:159], v27 offset:31232
    v_accvgpr_write_b32 a80, v112
    v_cvt_pk_bf16_f32 v113, v130, v131
    v_mfma_f32_32x32x16_bf16 v[32:47], a[252:255], a[184:187], v[32:47]
    v_accvgpr_write_b32 a81, v113
    v_cvt_pk_bf16_f32 v114, v132, v133
    v_accvgpr_write_b32 a82, v114
    v_mfma_f32_32x32x16_bf16 v[48:63], a[252:255], a[188:191], v[48:63]
    v_cvt_pk_bf16_f32 v115, v134, v135
    v_accvgpr_write_b32 a83, v115
    s_waitcnt lgkmcnt(0)
    s_waitcnt vmcnt(8)
    s_barrier
    s_cmp_lg_u32 s68, 0
    s_cbranch_scc1 L_nosig
    s_mov_b64 exec, 1
    v_mov_b32 v1, s83
    buffer_store_dword v1, off, s[28:31], s44 sc1
    s_mov_b64 exec, -1
L_nosig:
    s_nop 3
    v_mfma_f32_32x32x16_bf16 v[192:207], a[192:195], a[128:131], 0
    s_add_u32 m0, s70, 4096
    s_add_u32 s80, s93, 196608
    buffer_load_dwordx4 v13, s[24:27], s80 offen offset:0 lds
    v_mfma_f32_32x32x16_bf16 v[208:223], a[192:195], a[132:135], 0
    buffer_load_dwordx4 v14, s[24:27], s80 offen offset:1024 lds
    v_mfma_f32_32x32x16_bf16 v[224:239], a[224:227], a[128:131], 0
    buffer_load_dwordx4 v15, s[24:27], s80 offen offset:2048 lds
    v_mfma_f32_32x32x16_bf16 v[240:255], a[224:227], a[132:135], 0
    buffer_load_dwordx4 v16, s[24:27], s80 offen offset:3072 lds
    v_cvt_pk_bf16_f32 v116, v136, v137
    v_accvgpr_write_b32 a84, v116
    v_cvt_pk_bf16_f32 v117, v138, v139
    v_accvgpr_write_b32 a85, v117
    v_mfma_f32_32x32x16_bf16 v[192:207], a[196:199], a[136:139], v[192:207]
    s_add_u32 m0, s70, 28672
    s_add_u32 s80, s94, 0
    buffer_load_dwordx4 v13, s[24:27], s80 offen offset:0 lds
    v_cvt_pk_bf16_f32 v118, v140, v141
    v_accvgpr_write_b32 a86, v118
    v_cvt_pk_bf16_f32 v119, v142, v143
    v_mfma_f32_32x32x16_bf16 v[208:223], a[196:199], a[140:143], v[208:223]
    buffer_load_dwordx4 v14, s[24:27], s80 offen offset:1024 lds
    v_accvgpr_write_b32 a87, v119
    v_cvt_pk_bf16_f32 v120, v144, v145
    v_accvgpr_write_b32 a88, v120
    v_mfma_f32_32x32x16_bf16 v[224:239], a[228:231], a[136:139], v[224:239]
    buffer_load_dwordx4 v15, s[24:27], s80 offen offset:2048 lds
    v_cvt_pk_bf16_f32 v121, v146, v147
    v_accvgpr_write_b32 a89, v121
    v_cvt_pk_bf16_f32 v122, v148, v149
    v_mfma_f32_32x32x16_bf16 v[240:255], a[228:231], a[140:143], v[240:255]
    buffer_load_dwordx4 v16, s[24:27], s80 offen offset:3072 lds
    s_waitcnt vmcnt(22)
    ds_read_b64_tr_b16 a[160:161], v26 offset:12288
    ds_read_b64_tr_b16 a[162:163], v26 offset:12800
    v_accvgpr_write_b32 a90, v122
    v_cvt_pk_bf16_f32 v123, v150, v151
    v_accvgpr_write_b32 a91, v123
    v_mfma_f32_32x32x16_bf16 v[192:207], a[200:203], a[144:147], v[192:207]
    ds_read_b64_tr_b16 a[164:165], v27 offset:12288
    ds_read_b64_tr_b16 a[166:167], v27 offset:12800
    v_cvt_pk_bf16_f32 v124, v152, v153
    v_accvgpr_write_b32 a92, v124
    v_cvt_pk_bf16_f32 v125, v154, v155
    v_mfma_f32_32x32x16_bf16 v[208:223], a[200:203], a[148:151], v[208:223]
    ds_read_b64_tr_b16 a[168:169], v26 offset:14336
    ds_read_b64_tr_b16 a[170:171], v26 offset:14848
    ds_read_b64_tr_b16 a[172:173], v27 offset:14336
    v_accvgpr_write_b32 a93, v125
    v_cvt_pk_bf16_f32 v126, v156, v157
    v_accvgpr_write_b32 a94, v126
    v_mfma_f32_32x32x16_bf16 v[224:239], a[232:235], a[144:147], v[224:239]
    ds_read_b64_tr_b16 a[174:175], v27 offset:14848
    ds_read_b64_tr_b16 a[176:177], v26 offset:8192
    v_cvt_pk_bf16_f32 v127, v158, v159
    v_accvgpr_write_b32 a95, v127
    v_cvt_pk_bf16_f32 v160, v160, v161
    v_mfma_f32_32x32x16_bf16 v[240:255], a[232:235], a[148:151], v[240:255]
    ds_read_b64_tr_b16 a[178:179], v26 offset:8704
    ds_read_b64_tr_b16 a[180:181], v27 offset:8192
    ds_read_b64_tr_b16 a[182:183], v27 offset:8704
    v_accvgpr_write_b32 a96, v160
    v_cvt_pk_bf16_f32 v161, v162, v163
    v_accvgpr_write_b32 a97, v161
    v_mfma_f32_32x32x16_bf16 v[192:207], a[204:207], a[152:155], v[192:207]
    ds_read_b64_tr_b16 a[184:185], v26 offset:10240
    ds_read_b64_tr_b16 a[186:187], v26 offset:10752
    v_cvt_pk_bf16_f32 v162, v164, v165
    v_accvgpr_write_b32 a98, v162
    v_cvt_pk_bf16_f32 v163, v166, v167
    v_mfma_f32_32x32x16_bf16 v[208:223], a[204:207], a[156:159], v[208:223]
    ds_read_b64_tr_b16 a[188:189], v27 offset:10240
    ds_read_b64_tr_b16 a[190:191], v27 offset:10752
    v_accvgpr_write_b32 a99, v163
    v_cvt_pk_bf16_f32 v164, v168, v169
    v_accvgpr_write_b32 a100, v164
    v_mfma_f32_32x32x16_bf16 v[224:239], a[236:239], a[152:155], v[224:239]
    v_cvt_pk_bf16_f32 v165, v170, v171
    v_accvgpr_write_b32 a101, v165
    v_cvt_pk_bf16_f32 v166, v172, v173
    v_mfma_f32_32x32x16_bf16 v[240:255], a[236:239], a[156:159], v[240:255]
    v_accvgpr_write_b32 a102, v166
    v_cvt_pk_bf16_f32 v167, v174, v175
    v_accvgpr_write_b32 a103, v167
    s_waitcnt lgkmcnt(0)
    v_mfma_f32_32x32x16_bf16 v[192:207], a[208:211], a[160:163], v[192:207]
    s_add_u32 m0, s70, 16384
    s_add_u32 s80, s94, 65536
    buffer_load_dwordx4 v13, s[24:27], s80 offen offset:0 lds
    v_cvt_pk_bf16_f32 v168, v176, v177
    v_accvgpr_write_b32 a104, v168
    v_cvt_pk_bf16_f32 v169, v178, v179
    v_mfma_f32_32x32x16_bf16 v[208:223], a[208:211], a[164:167], v[208:223]
    buffer_load_dwordx4 v14, s[24:27], s80 offen offset:1024 lds
    v_accvgpr_write_b32 a105, v169
    v_cvt_pk_bf16_f32 v170, v180, v181
    v_mfma_f32_32x32x16_bf16 v[224:239], a[240:243], a[160:163], v[224:239]
    buffer_load_dwordx4 v15, s[24:27], s80 offen offset:2048 lds
    v_accvgpr_write_b32 a106, v170
    v_cvt_pk_bf16_f32 v171, v182, v183
    v_accvgpr_write_b32 a107, v171
    v_mfma_f32_32x32x16_bf16 v[240:255], a[240:243], a[164:167], v[240:255]
    buffer_load_dwordx4 v16, s[24:27], s80 offen offset:3072 lds
    v_cvt_pk_bf16_f32 v172, v184, v185
    v_accvgpr_write_b32 a108, v172
    v_mfma_f32_32x32x16_bf16 v[192:207], a[212:215], a[168:171], v[192:207]
    s_add_u32 m0, s70, 24576
    s_add_u32 s80, s94, 131072
    buffer_load_dwordx4 v13, s[24:27], s80 offen offset:0 lds
    v_cvt_pk_bf16_f32 v173, v186, v187
    v_accvgpr_write_b32 a109, v173
    v_cvt_pk_bf16_f32 v174, v188, v189
    v_mfma_f32_32x32x16_bf16 v[208:223], a[212:215], a[172:175], v[208:223]
    buffer_load_dwordx4 v14, s[24:27], s80 offen offset:1024 lds
    v_accvgpr_write_b32 a110, v174
    v_cvt_pk_bf16_f32 v175, v190, v191
    v_mfma_f32_32x32x16_bf16 v[224:239], a[244:247], a[168:171], v[224:239]
    buffer_load_dwordx4 v15, s[24:27], s80 offen offset:2048 lds
    v_accvgpr_write_b32 a111, v175
    v_cvt_pk_bf16_f32 v176, v32, v33
    v_accvgpr_write_b32 a112, v176
    v_mfma_f32_32x32x16_bf16 v[240:255], a[244:247], a[172:175], v[240:255]
    buffer_load_dwordx4 v16, s[24:27], s80 offen offset:3072 lds
    s_waitcnt vmcnt(20)
    ds_read_b64_tr_b16 a[128:129], v26 offset:32768
    ds_read_b64_tr_b16 a[130:131], v26 offset:33280
    v_cvt_pk_bf16_f32 v177, v34, v35
    v_accvgpr_write_b32 a113, v177
    v_mfma_f32_32x32x16_bf16 v[192:207], a[216:219], a[176:179], v[192:207]
    ds_read_b64_tr_b16 a[132:133], v27 offset:32768
    ds_read_b64_tr_b16 a[134:135], v27 offset:33280
    v_cvt_pk_bf16_f32 v178, v36, v37
    v_accvgpr_write_b32 a114, v178
    v_cvt_pk_bf16_f32 v179, v38, v39
    v_mfma_f32_32x32x16_bf16 v[208:223], a[216:219], a[180:183], v[208:223]
    ds_read_b64_tr_b16 a[136:137], v26 offset:34816
    ds_read_b64_tr_b16 a[138:139], v26 offset:35328
    ds_read_b64_tr_b16 a[140:141], v27 offset:34816
    v_accvgpr_write_b32 a115, v179
    v_cvt_pk_bf16_f32 v180, v40, v41
    v_mfma_f32_32x32x16_bf16 v[224:239], a[248:251], a[176:179], v[224:239]
    ds_read_b64_tr_b16 a[142:143], v27 offset:35328
    ds_read_b64_tr_b16 a[144:145], v26 offset:36864
    v_accvgpr_write_b32 a116, v180
    v_cvt_pk_bf16_f32 v181, v42, v43
    v_accvgpr_write_b32 a117, v181
    v_mfma_f32_32x32x16_bf16 v[240:255], a[248:251], a[180:183], v[240:255]
    ds_read_b64_tr_b16 a[146:147], v26 offset:37376
    ds_read_b64_tr_b16 a[148:149], v27 offset:36864
    ds_read_b64_tr_b16 a[150:151], v27 offset:37376
    v_cvt_pk_bf16_f32 v182, v44, v45
    v_accvgpr_write_b32 a118, v182
    v_mfma_f32_32x32x16_bf16 v[192:207], a[220:223], a[184:187], v[192:207]
    ds_read_b64_tr_b16 a[152:153], v26 offset:38912
    ds_read_b64_tr_b16 a[154:155], v26 offset:39424
    v_cvt_pk_bf16_f32 v183, v46, v47
    v_accvgpr_write_b32 a119, v183
    v_cvt_pk_bf16_f32 v184, v48, v49
    v_mfma_f32_32x32x16_bf16 v[208:223], a[220:223], a[188:191], v[208:223]
    ds_read_b64_tr_b16 a[156:157], v27 offset:38912
    ds_read_b64_tr_b16 a[158:159], v27 offset:39424
    v_accvgpr_write_b32 a120, v184
    v_cvt_pk_bf16_f32 v185, v50, v51
    v_mfma_f32_32x32x16_bf16 v[224:239], a[252:255], a[184:187], v[224:239]
    v_accvgpr_write_b32 a121, v185
    v_cvt_pk_bf16_f32 v186, v52, v53
    v_accvgpr_write_b32 a122, v186
    v_mfma_f32_32x32x16_bf16 v[240:255], a[252:255], a[188:191], v[240:255]
    v_cvt_pk_bf16_f32 v187, v54, v55
    v_accvgpr_write_b32 a123, v187
    s_waitcnt lgkmcnt(0)
    v_mfma_f32_32x32x16_bf16 v[96:111], a[192:195], a[128:131], 0
    s_add_u32 m0, s70, 20480
    s_add_u32 s80, s94, 196608
    buffer_load_dwordx4 v13, s[24:27], s80 offen offset:0 lds
    v_mfma_f32_32x32x16_bf16 v[112:127], a[192:195], a[132:135], 0
    buffer_load_dwordx4 v14, s[24:27], s80 offen offset:1024 lds
    v_mfma_f32_32x32x16_bf16 v[128:143], a[224:227], a[128:131], 0
    buffer_load_dwordx4 v15, s[24:27], s80 offen offset:2048 lds
    v_mfma_f32_32x32x16_bf16 v[144:159], a[224:227], a[132:135], 0
    buffer_load_dwordx4 v16, s[24:27], s80 offen offset:3072 lds
    v_cvt_pk_bf16_f32 v188, v56, v57
    v_accvgpr_write_b32 a124, v188
    v_cvt_pk_bf16_f32 v189, v58, v59
    v_accvgpr_write_b32 a125, v189
    v_mfma_f32_32x32x16_bf16 v[96:111], a[196:199], a[136:139], v[96:111]
    s_add_u32 m0, s70, 12288
    s_add_u32 s80, s95, 0
    buffer_load_dwordx4 v13, s[24:27], s80 offen offset:0 lds
    v_cvt_pk_bf16_f32 v190, v60, v61
    v_accvgpr_write_b32 a126, v190
    v_cvt_pk_bf16_f32 v191, v62, v63
    v_mfma_f32_32x32x16_bf16 v[112:127], a[196:199], a[140:143], v[112:127]
    buffer_load_dwordx4 v14, s[24:27], s80 offen offset:1024 lds
    v_accvgpr_write_b32 a127, v191
    v_cvt_pk_bf16_f32 v192, v192, v193
    v_accvgpr_write_b32 a0, v192
    v_mfma_f32_32x32x16_bf16 v[128:143], a[228:231], a[136:139], v[128:143]
    buffer_load_dwordx4 v15, s[24:27], s80 offen offset:2048 lds
    v_cvt_pk_bf16_f32 v193, v194, v195
    v_accvgpr_write_b32 a1, v193
    v_cvt_pk_bf16_f32 v194, v196, v197
    v_mfma_f32_32x32x16_bf16 v[144:159], a[228:231], a[140:143], v[144:159]
    buffer_load_dwordx4 v16, s[24:27], s80 offen offset:3072 lds
    s_waitcnt vmcnt(20)
    ds_read_b64_tr_b16 a[160:161], v26 offset:0
    ds_read_b64_tr_b16 a[162:163], v26 offset:512
    v_accvgpr_write_b32 a2, v194
    v_cvt_pk_bf16_f32 v195, v198, v199
    v_accvgpr_write_b32 a3, v195
    v_mfma_f32_32x32x16_bf16 v[96:111], a[200:203], a[144:147], v[96:111]
    ds_read_b64_tr_b16 a[164:165], v27 offset:0
    ds_read_b64_tr_b16 a[166:167], v27 offset:512
    v_cvt_pk_bf16_f32 v196, v200, v201
    v_accvgpr_write_b32 a4, v196
    v_cvt_pk_bf16_f32 v197, v202, v203
    v_mfma_f32_32x32x16_bf16 v[112:127], a[200:203], a[148:151], v[112:127]
    ds_read_b64_tr_b16 a[168:169], v26 offset:2048
    ds_read_b64_tr_b16 a[170:171], v26 offset:2560
    ds_read_b64_tr_b16 a[172:173], v27 offset:2048
    v_accvgpr_write_b32 a5, v197
    v_cvt_pk_bf16_f32 v198, v204, v205
    v_accvgpr_write_b32 a6, v198
    v_mfma_f32_32x32x16_bf16 v[128:143], a[232:235], a[144:147], v[128:143]
    ds_read_b64_tr_b16 a[174:175], v27 offset:2560
    ds_read_b64_tr_b16 a[176:177], v26 offset:4096
    v_cvt_pk_bf16_f32 v199, v206, v207
    v_accvgpr_write_b32 a7, v199
    v_cvt_pk_bf16_f32 v200, v208, v209
    v_mfma_f32_32x32x16_bf16 v[144:159], a[232:235], a[148:151], v[144:159]
    ds_read_b64_tr_b16 a[178:179], v26 offset:4608
    ds_read_b64_tr_b16 a[180:181], v27 offset:4096
    ds_read_b64_tr_b16 a[182:183], v27 offset:4608
    v_accvgpr_write_b32 a8, v200
    v_cvt_pk_bf16_f32 v201, v210, v211
    v_accvgpr_write_b32 a9, v201
    v_mfma_f32_32x32x16_bf16 v[96:111], a[204:207], a[152:155], v[96:111]
    ds_read_b64_tr_b16 a[184:185], v26 offset:6144
    ds_read_b64_tr_b16 a[186:187], v26 offset:6656
    v_cvt_pk_bf16_f32 v202, v212, v213
    v_accvgpr_write_b32 a10, v202
    v_cvt_pk_bf16_f32 v203, v214, v215
    v_mfma_f32_32x32x16_bf16 v[112:127], a[204:207], a[156:159], v[112:127]
    ds_read_b64_tr_b16 a[188:189], v27 offset:6144
    ds_read_b64_tr_b16 a[190:191], v27 offset:6656
    v_accvgpr_write_b32 a11, v203
    v_cvt_pk_bf16_f32 v204, v216, v217
    v_accvgpr_write_b32 a12, v204
    v_mfma_f32_32x32x16_bf16 v[128:143], a[236:239], a[152:155], v[128:143]
    v_cvt_pk_bf16_f32 v205, v218, v219
    v_accvgpr_write_b32 a13, v205
    v_cvt_pk_bf16_f32 v206, v220, v221
    v_mfma_f32_32x32x16_bf16 v[144:159], a[236:239], a[156:159], v[144:159]
    v_accvgpr_write_b32 a14, v206
    v_cvt_pk_bf16_f32 v207, v222, v223
    v_accvgpr_write_b32 a15, v207
    s_waitcnt lgkmcnt(0)
    v_mfma_f32_32x32x16_bf16 v[96:111], a[208:211], a[160:163], v[96:111]
    s_add_u32 m0, s70, 8192
    s_add_u32 s80, s95, 65536
    buffer_load_dwordx4 v13, s[24:27], s80 offen offset:0 lds
    v_cvt_pk_bf16_f32 v208, v224, v225
    v_accvgpr_write_b32 a16, v208
    v_mfma_f32_32x32x16_bf16 v[112:127], a[208:211], a[164:167], v[112:127]
    buffer_load_dwordx4 v14, s[24:27], s80 offen offset:1024 lds
    v_cvt_pk_bf16_f32 v209, v226, v227
    v_accvgpr_write_b32 a17, v209
    v_mfma_f32_32x32x16_bf16 v[128:143], a[240:243], a[160:163], v[128:143]
    buffer_load_dwordx4 v15, s[24:27], s80 offen offset:2048 lds
    v_cvt_pk_bf16_f32 v210, v228, v229
    v_accvgpr_write_b32 a18, v210
    v_mfma_f32_32x32x16_bf16 v[144:159], a[240:243], a[164:167], v[144:159]
    buffer_load_dwordx4 v16, s[24:27], s80 offen offset:3072 lds
    v_cvt_pk_bf16_f32 v211, v230, v231
    v_accvgpr_write_b32 a19, v211
    v_mfma_f32_32x32x16_bf16 v[96:111], a[212:215], a[168:171], v[96:111]
    s_add_u32 m0, s70, 32768
    s_add_u32 s80, s95, 131072
    buffer_load_dwordx4 v13, s[24:27], s80 offen offset:0 lds
    v_cvt_pk_bf16_f32 v212, v232, v233
    v_accvgpr_write_b32 a20, v212
    v_mfma_f32_32x32x16_bf16 v[112:127], a[212:215], a[172:175], v[112:127]
    buffer_load_dwordx4 v14, s[24:27], s80 offen offset:1024 lds
    v_cvt_pk_bf16_f32 v213, v234, v235
    v_accvgpr_write_b32 a21, v213
    v_mfma_f32_32x32x16_bf16 v[128:143], a[244:247], a[168:171], v[128:143]
    buffer_load_dwordx4 v15, s[24:27], s80 offen offset:2048 lds
    v_cvt_pk_bf16_f32 v214, v236, v237
    v_accvgpr_write_b32 a22, v214
    v_mfma_f32_32x32x16_bf16 v[144:159], a[244:247], a[172:175], v[144:159]
    buffer_load_dwordx4 v16, s[24:27], s80 offen offset:3072 lds
    s_waitcnt vmcnt(20)
    ds_read_b64_tr_b16 a[128:129], v26 offset:28672
    ds_read_b64_tr_b16 a[130:131], v26 offset:29184
    v_cvt_pk_bf16_f32 v215, v238, v239
    v_accvgpr_write_b32 a23, v215
    v_mfma_f32_32x32x16_bf16 v[96:111], a[216:219], a[176:179], v[96:111]
    ds_read_b64_tr_b16 a[132:133], v27 offset:28672
    ds_read_b64_tr_b16 a[134:135], v27 offset:29184
    v_cvt_pk_bf16_f32 v216, v240, v241
    v_accvgpr_write_b32 a24, v216
    v_mfma_f32_32x32x16_bf16 v[112:127], a[216:219], a[180:183], v[112:127]
    ds_read_b64_tr_b16 a[136:137], v26 offset:30720
    ds_read_b64_tr_b16 a[138:139], v26 offset:31232
    ds_read_b64_tr_b16 a[140:141], v27 offset:30720
    v_cvt_pk_bf16_f32 v217, v242, v243
    v_accvgpr_write_b32 a25, v217
    v_mfma_f32_32x32x16_bf16 v[128:143], a[248:251], a[176:179], v[128:143]
    ds_read_b64_tr_b16 a[142:143], v27 offset:31232
    ds_read_b64_tr_b16 a[144:145], v26 offset:16384
    v_cvt_pk_bf16_f32 v218, v244, v245
    v_accvgpr_write_b32 a26, v218
    v_mfma_f32_32x32x16_bf16 v[144:159], a[248:251], a[180:183], v[144:159]
    ds_read_b64_tr_b16 a[146:147], v26 offset:16896
    ds_read_b64_tr_b16 a[148:149], v27 offset:16384
    ds_read_b64_tr_b16 a[150:151], v27 offset:16896
    v_cvt_pk_bf16_f32 v219, v246, v247
    v_accvgpr_write_b32 a27, v219
    v_mfma_f32_32x32x16_bf16 v[96:111], a[220:223], a[184:187], v[96:111]
    ds_read_b64_tr_b16 a[152:153], v26 offset:18432
    ds_read_b64_tr_b16 a[154:155], v26 offset:18944
    v_cvt_pk_bf16_f32 v220, v248, v249
    v_accvgpr_write_b32 a28, v220
    v_mfma_f32_32x32x16_bf16 v[112:127], a[220:223], a[188:191], v[112:127]
    ds_read_b64_tr_b16 a[156:157], v27 offset:18432
    ds_read_b64_tr_b16 a[158:159], v27 offset:18944
    v_cvt_pk_bf16_f32 v221, v250, v251
    v_accvgpr_write_b32 a29, v221
    v_mfma_f32_32x32x16_bf16 v[128:143], a[252:255], a[184:187], v[128:143]
    v_cvt_pk_bf16_f32 v222, v252, v253
    v_accvgpr_write_b32 a30, v222
    v_mfma_f32_32x32x16_bf16 v[144:159], a[252:255], a[188:191], v[144:159]
    v_cvt_pk_bf16_f32 v223, v254, v255
    v_accvgpr_write_b32 a31, v223
    s_waitcnt lgkmcnt(0)
    v_mfma_f32_32x32x16_bf16 v[160:175], a[192:195], a[128:131], 0
    s_add_u32 m0, s70, 36864
    s_add_u32 s80, s95, 196608
    buffer_load_dwordx4 v13, s[24:27], s80 offen offset:0 lds
    v_mfma_f32_32x32x16_bf16 v[176:191], a[192:195], a[132:135], 0
    buffer_load_dwordx4 v14, s[24:27], s80 offen offset:1024 lds
    v_mfma_f32_32x32x16_bf16 v[32:47], a[224:227], a[128:131], 0
    buffer_load_dwordx4 v15, s[24:27], s80 offen offset:2048 lds
    v_mfma_f32_32x32x16_bf16 v[48:63], a[224:227], a[132:135], 0
    buffer_load_dwordx4 v16, s[24:27], s80 offen offset:3072 lds
    v_cvt_pk_bf16_f32 v96, v96, v97
    v_cvt_pk_bf16_f32 v97, v98, v99
    v_cvt_pk_bf16_f32 v98, v100, v101
    v_mfma_f32_32x32x16_bf16 v[160:175], a[196:199], a[136:139], v[160:175]
    s_add_u32 m0, s70, 0
    s_add_u32 s80, s96, 0
    buffer_load_dwordx4 v13, s[24:27], s80 offen offset:0 lds
    v_cvt_pk_bf16_f32 v99, v102, v103
    v_cvt_pk_bf16_f32 v100, v104, v105
    v_mfma_f32_32x32x16_bf16 v[176:191], a[196:199], a[140:143], v[176:191]
    buffer_load_dwordx4 v14, s[24:27], s80 offen offset:1024 lds
    v_cvt_pk_bf16_f32 v101, v106, v107
    v_cvt_pk_bf16_f32 v102, v108, v109
    v_cvt_pk_bf16_f32 v103, v110, v111
    v_mfma_f32_32x32x16_bf16 v[32:47], a[228:231], a[136:139], v[32:47]
    buffer_load_dwordx4 v15, s[24:27], s80 offen offset:2048 lds
    v_cvt_pk_bf16_f32 v104, v112, v113
    v_cvt_pk_bf16_f32 v105, v114, v115
    v_mfma_f32_32x32x16_bf16 v[48:63], a[228:231], a[140:143], v[48:63]
    buffer_load_dwordx4 v16, s[24:27], s80 offen offset:3072 lds
    s_waitcnt vmcnt(20)
    ds_read_b64_tr_b16 a[160:161], v26 offset:24576
    ds_read_b64_tr_b16 a[162:163], v26 offset:25088
    v_cvt_pk_bf16_f32 v106, v116, v117
    v_cvt_pk_bf16_f32 v107, v118, v119
    v_cvt_pk_bf16_f32 v108, v120, v121
    v_mfma_f32_32x32x16_bf16 v[160:175], a[200:203], a[144:147], v[160:175]
    ds_read_b64_tr_b16 a[164:165], v27 offset:24576
    ds_read_b64_tr_b16 a[166:167], v27 offset:25088
    v_cvt_pk_bf16_f32 v109, v122, v123
    v_cvt_pk_bf16_f32 v110, v124, v125
    v_mfma_f32_32x32x16_bf16 v[176:191], a[200:203], a[148:151], v[176:191]
    ds_read_b64_tr_b16 a[168:169], v26 offset:26624
    ds_read_b64_tr_b16 a[170:171], v26 offset:27136
    ds_read_b64_tr_b16 a[172:173], v27 offset:26624
    v_cvt_pk_bf16_f32 v111, v126, v127
    v_cvt_pk_bf16_f32 v112, v128, v129
    v_cvt_pk_bf16_f32 v113, v130, v131
    v_mfma_f32_32x32x16_bf16 v[32:47], a[232:235], a[144:147], v[32:47]
    ds_read_b64_tr_b16 a[174:175], v27 offset:27136
    ds_read_b64_tr_b16 a[176:177], v26 offset:20480
    v_cvt_pk_bf16_f32 v114, v132, v133
    v_cvt_pk_bf16_f32 v115, v134, v135
    v_mfma_f32_32x32x16_bf16 v[48:63], a[232:235], a[148:151], v[48:63]
    ds_read_b64_tr_b16 a[178:179], v26 offset:20992
    ds_read_b64_tr_b16 a[180:181], v27 offset:20480
    ds_read_b64_tr_b16 a[182:183], v27 offset:20992
    v_cvt_pk_bf16_f32 v116, v136, v137
    v_cvt_pk_bf16_f32 v117, v138, v139
    v_cvt_pk_bf16_f32 v118, v140, v141
    v_mfma_f32_32x32x16_bf16 v[160:175], a[204:207], a[152:155], v[160:175]
    ds_read_b64_tr_b16 a[184:185], v26 offset:22528
    ds_read_b64_tr_b16 a[186:187], v26 offset:23040
    v_cvt_pk_bf16_f32 v119, v142, v143
    v_cvt_pk_bf16_f32 v120, v144, v145
    v_mfma_f32_32x32x16_bf16 v[176:191], a[204:207], a[156:159], v[176:191]
    ds_read_b64_tr_b16 a[188:189], v27 offset:22528
    ds_read_b64_tr_b16 a[190:191], v27 offset:23040
    v_cvt_pk_bf16_f32 v121, v146, v147
    v_cvt_pk_bf16_f32 v122, v148, v149
    v_cvt_pk_bf16_f32 v123, v150, v151
    v_mfma_f32_32x32x16_bf16 v[32:47], a[236:239], a[152:155], v[32:47]
    v_cvt_pk_bf16_f32 v124, v152, v153
    v_cvt_pk_bf16_f32 v125, v154, v155
    v_mfma_f32_32x32x16_bf16 v[48:63], a[236:239], a[156:159], v[48:63]
    v_cvt_pk_bf16_f32 v126, v156, v157
    v_cvt_pk_bf16_f32 v127, v158, v159
    s_waitcnt lgkmcnt(0)
    v_mfma_f32_32x32x16_bf16 v[160:175], a[208:211], a[160:163], v[160:175]
    s_add_u32 m0, s70, 4096
    s_add_u32 s80, s96, 65536
    buffer_load_dwordx4 v13, s[24:27], s80 offen offset:0 lds
    v_mfma_f32_32x32x16_bf16 v[176:191], a[208:211], a[164:167], v[176:191]
    buffer_load_dwordx4 v14, s[24:27], s80 offen offset:1024 lds
    v_mfma_f32_32x32x16_bf16 v[32:47], a[240:243], a[160:163], v[32:47]
    buffer_load_dwordx4 v15, s[24:27], s80 offen offset:2048 lds
    v_mfma_f32_32x32x16_bf16 v[48:63], a[240:243], a[164:167], v[48:63]
    buffer_load_dwordx4 v16, s[24:27], s80 offen offset:3072 lds
    v_mfma_f32_32x32x16_bf16 v[160:175], a[212:215], a[168:171], v[160:175]
    s_add_u32 m0, s70, 28672
    s_add_u32 s80, s96, 131072
    buffer_load_dwordx4 v13, s[24:27], s80 offen offset:0 lds
    v_mfma_f32_32x32x16_bf16 v[176:191], a[212:215], a[172:175], v[176:191]
    buffer_load_dwordx4 v14, s[24:27], s80 offen offset:1024 lds
    v_mfma_f32_32x32x16_bf16 v[32:47], a[244:247], a[168:171], v[32:47]
    buffer_load_dwordx4 v15, s[24:27], s80 offen offset:2048 lds
    v_mfma_f32_32x32x16_bf16 v[48:63], a[244:247], a[172:175], v[48:63]
    buffer_load_dwordx4 v16, s[24:27], s80 offen offset:3072 lds
    s_waitcnt vmcnt(20)
    ds_read_b64_tr_b16 a[128:129], v26 offset:12288
    ds_read_b64_tr_b16 a[130:131], v26 offset:12800
    v_mfma_f32_32x32x16_bf16 v[160:175], a[216:219], a[176:179], v[160:175]
    ds_read_b64_tr_b16 a[132:133], v27 offset:12288
    ds_read_b64_tr_b16 a[134:135], v27 offset:12800
    v_mfma_f32_32x32x16_bf16 v[176:191], a[216:219], a[180:183], v[176:191]
    ds_read_b64_tr_b16 a[136:137], v26 offset:14336
    ds_read_b64_tr_b16 a[138:139], v26 offset:14848
    ds_read_b64_tr_b16 a[140:141], v27 offset:14336
    v_mfma_f32_32x32x16_bf16 v[32:47], a[248:251], a[176:179], v[32:47]
    ds_read_b64_tr_b16 a[142:143], v27 offset:14848
    ds_read_b64_tr_b16 a[144:145], v26 offset:8192
    v_mfma_f32_32x32x16_bf16 v[48:63], a[248:251], a[180:183], v[48:63]
    ds_read_b64_tr_b16 a[146:147], v26 offset:8704
    ds_read_b64_tr_b16 a[148:149], v27 offset:8192
    ds_read_b64_tr_b16 a[150:151], v27 offset:8704
    v_mfma_f32_32x32x16_bf16 v[160:175], a[220:223], a[184:187], v[160:175]
    ds_read_b64_tr_b16 a[152:153], v26 offset:10240
    ds_read_b64_tr_b16 a[154:155], v26 offset:10752
    v_mfma_f32_32x32x16_bf16 v[176:191], a[220:223], a[188:191], v[176:191]
    ds_read_b64_tr_b16 a[156:157], v27 offset:10240
    ds_read_b64_tr_b16 a[158:159], v27 offset:10752
    v_mfma_f32_32x32x16_bf16 v[32:47], a[252:255], a[184:187], v[32:47]
    v_mfma_f32_32x32x16_bf16 v[48:63], a[252:255], a[188:191], v[48:63]
    s_waitcnt lgkmcnt(0)
    v_and_b32 v3, 7, v0
    v_lshlrev_b32 v3, 2, v3
    buffer_load_dword v2, v3, s[28:31], s45 offen sc1
    v_mfma_f32_32x32x16_bf16 v[192:207], a[192:195], a[128:131], 0
    s_add_u32 m0, s70, 16384
    s_add_u32 s80, s96, 196608
    buffer_load_dwordx4 v13, s[24:27], s80 offen offset:0 lds
    v_mfma_f32_32x32x16_bf16 v[208:223], a[192:195], a[132:135], 0
    buffer_load_dwordx4 v14, s[24:27], s80 offen offset:1024 lds
    v_mfma_f32_32x32x16_bf16 v[224:239], a[224:227], a[128:131], 0
    buffer_load_dwordx4 v15, s[24:27], s80 offen offset:2048 lds
    v_mfma_f32_32x32x16_bf16 v[240:255], a[224:227], a[132:135], 0
    buffer_load_dwordx4 v16, s[24:27], s80 offen offset:3072 lds
    v_cvt_pk_bf16_f32 v160, v160, v161
    v_cvt_pk_bf16_f32 v161, v162, v163
    v_cvt_pk_bf16_f32 v162, v164, v165
    v_mfma_f32_32x32x16_bf16 v[192:207], a[196:199], a[136:139], v[192:207]
    s_add_u32 m0, s70, 24576
    s_add_u32 s80, s97, 0
    buffer_load_dwordx4 v13, s[24:27], s80 offen offset:0 lds
    v_cvt_pk_bf16_f32 v163, v166, v167
    v_cvt_pk_bf16_f32 v164, v168, v169
    v_mfma_f32_32x32x16_bf16 v[208:223], a[196:199], a[140:143], v[208:223]
    buffer_load_dwordx4 v14, s[24:27], s80 offen offset:1024 lds
    v_cvt_pk_bf16_f32 v165, v170, v171
    v_cvt_pk_bf16_f32 v166, v172, v173
    v_cvt_pk_bf16_f32 v167, v174, v175
    v_mfma_f32_32x32x16_bf16 v[224:239], a[228:231], a[136:139], v[224:239]
    buffer_load_dwordx4 v15, s[24:27], s80 offen offset:2048 lds
    v_cvt_pk_bf16_f32 v168, v176, v177
    v_cvt_pk_bf16_f32 v169, v178, v179
    v_mfma_f32_32x32x16_bf16 v[240:255], a[228:231], a[140:143], v[240:255]
    buffer_load_dwordx4 v16, s[24:27], s80 offen offset:3072 lds
    s_waitcnt vmcnt(21)
    ds_read_b64_tr_b16 a[160:161], v26 offset:32768
    ds_read_b64_tr_b16 a[162:163], v26 offset:33280
    v_cvt_pk_bf16_f32 v170, v180, v181
    v_cvt_pk_bf16_f32 v171, v182, v183
    v_cvt_pk_bf16_f32 v172, v184, v185
    v_mfma_f32_32x32x16_bf16 v[192:207], a[200:203], a[144:147], v[192:207]
    ds_read_b64_tr_b16 a[164:165], v27 offset:32768
    ds_read_b64_tr_b16 a[166:167], v27 offset:33280
    v_cvt_pk_bf16_f32 v173, v186, v187
    v_cvt_pk_bf16_f32 v174, v188, v189
    v_mfma_f32_32x32x16_bf16 v[208:223], a[200:203], a[148:151], v[208:223]
    ds_read_b64_tr_b16 a[168:169], v26 offset:34816
    ds_read_b64_tr_b16 a[170:171], v26 offset:35328
    ds_read_b64_tr_b16 a[172:173], v27 offset:34816
    v_cvt_pk_bf16_f32 v175, v190, v191
    v_cvt_pk_bf16_f32 v176, v32, v33
    v_cvt_pk_bf16_f32 v177, v34, v35
    v_mfma_f32_32x32x16_bf16 v[224:239], a[232:235], a[144:147], v[224:239]
    ds_read_b64_tr_b16 a[174:175], v27 offset:35328
    ds_read_b64_tr_b16 a[176:177], v26 offset:36864
    v_cvt_pk_bf16_f32 v178, v36, v37
    v_cvt_pk_bf16_f32 v179, v38, v39
    v_mfma_f32_32x32x16_bf16 v[240:255], a[232:235], a[148:151], v[240:255]
    ds_read_b64_tr_b16 a[178:179], v26 offset:37376
    ds_read_b64_tr_b16 a[180:181], v27 offset:36864
    ds_read_b64_tr_b16 a[182:183], v27 offset:37376
    v_cvt_pk_bf16_f32 v180, v40, v41
    v_cvt_pk_bf16_f32 v181, v42, v43
    v_cvt_pk_bf16_f32 v182, v44, v45
    v_mfma_f32_32x32x16_bf16 v[192:207], a[204:207], a[152:155], v[192:207]
    ds_read_b64_tr_b16 a[184:185], v26 offset:38912
    ds_read_b64_tr_b16 a[186:187], v26 offset:39424
    v_cvt_pk_bf16_f32 v183, v46, v47
    v_cvt_pk_bf16_f32 v184, v48, v49
    v_mfma_f32_32x32x16_bf16 v[208:223], a[204:207], a[156:159], v[208:223]
    ds_read_b64_tr_b16 a[188:189], v27 offset:38912
    ds_read_b64_tr_b16 a[190:191], v27 offset:39424
    v_cvt_pk_bf16_f32 v185, v50, v51
    v_cvt_pk_bf16_f32 v186, v52, v53
    v_cvt_pk_bf16_f32 v187, v54, v55
    v_mfma_f32_32x32x16_bf16 v[224:239], a[236:239], a[152:155], v[224:239]
    v_cvt_pk_bf16_f32 v188, v56, v57
    v_cvt_pk_bf16_f32 v189, v58, v59
    v_mfma_f32_32x32x16_bf16 v[240:255], a[236:239], a[156:159], v[240:255]
    v_cvt_pk_bf16_f32 v190, v60, v61
    v_cvt_pk_bf16_f32 v191, v62, v63
    s_waitcnt lgkmcnt(0)
    v_mfma_f32_32x32x16_bf16 v[192:207], a[208:211], a[160:163], v[192:207]
    s_add_u32 m0, s70, 20480
    s_add_u32 s80, s97, 65536
    buffer_load_dwordx4 v13, s[24:27], s80 offen offset:0 lds
    v_mfma_f32_32x32x16_bf16 v[208:223], a[208:211], a[164:167], v[208:223]
    buffer_load_dwordx4 v14, s[24:27], s80 offen offset:1024 lds
    v_mfma_f32_32x32x16_bf16 v[224:239], a[240:243], a[160:163], v[224:239]
    buffer_load_dwordx4 v15, s[24:27], s80 offen offset:2048 lds
    v_mfma_f32_32x32x16_bf16 v[240:255], a[240:243], a[164:167], v[240:255]
    buffer_load_dwordx4 v16, s[24:27], s80 offen offset:3072 lds
    v_mfma_f32_32x32x16_bf16 v[192:207], a[212:215], a[168:171], v[192:207]
    s_add_u32 m0, s70, 12288
    s_add_u32 s80, s97, 131072
    buffer_load_dwordx4 v13, s[24:27], s80 offen offset:0 lds
    v_mfma_f32_32x32x16_bf16 v[208:223], a[212:215], a[172:175], v[208:223]
    buffer_load_dwordx4 v14, s[24:27], s80 offen offset:1024 lds
    v_mfma_f32_32x32x16_bf16 v[224:239], a[244:247], a[168:171], v[224:239]
    buffer_load_dwordx4 v15, s[24:27], s80 offen offset:2048 lds
    v_mfma_f32_32x32x16_bf16 v[240:255], a[244:247], a[172:175], v[240:255]
    buffer_load_dwordx4 v16, s[24:27], s80 offen offset:3072 lds
    s_waitcnt vmcnt(21)
    ds_read_b64_tr_b16 a[128:129], v26 offset:0
    ds_read_b64_tr_b16 a[130:131], v26 offset:512
    v_mfma_f32_32x32x16_bf16 v[192:207], a[216:219], a[176:179], v[192:207]
    ds_read_b64_tr_b16 a[132:133], v27 offset:0
    ds_read_b64_tr_b16 a[134:135], v27 offset:512
    v_mfma_f32_32x32x16_bf16 v[208:223], a[216:219], a[180:183], v[208:223]
    ds_read_b64_tr_b16 a[136:137], v26 offset:2048
    ds_read_b64_tr_b16 a[138:139], v26 offset:2560
    ds_read_b64_tr_b16 a[140:141], v27 offset:2048
    v_mfma_f32_32x32x16_bf16 v[224:239], a[248:251], a[176:179], v[224:239]
    ds_read_b64_tr_b16 a[142:143], v27 offset:2560
    ds_read_b64_tr_b16 a[144:145], v26 offset:4096
    v_mfma_f32_32x32x16_bf16 v[240:255], a[248:251], a[180:183], v[240:255]
    ds_read_b64_tr_b16 a[146:147], v26 offset:4608
    ds_read_b64_tr_b16 a[148:149], v27 offset:4096
    ds_read_b64_tr_b16 a[150:151], v27 offset:4608
    v_mfma_f32_32x32x16_bf16 v[192:207], a[220:223], a[184:187], v[192:207]
    ds_read_b64_tr_b16 a[152:153], v26 offset:6144
    ds_read_b64_tr_b16 a[154:155], v26 offset:6656
    v_mfma_f32_32x32x16_bf16 v[208:223], a[220:223], a[188:191], v[208:223]
    ds_read_b64_tr_b16 a[156:157], v27 offset:6144
    ds_read_b64_tr_b16 a[158:159], v27 offset:6656
    v_mfma_f32_32x32x16_bf16 v[224:239], a[252:255], a[184:187], v[224:239]
    v_mfma_f32_32x32x16_bf16 v[240:255], a[252:255], a[188:191], v[240:255]
    s_waitcnt lgkmcnt(0)
    s_waitcnt vmcnt(16)
    v_cmp_ne_u32 vcc, s83, v2
    s_nop 1
    s_cmp_eq_u64 vcc, 0
    s_cbranch_scc1 L_ready
    s_mov_b32 s82, 0
L_spin:
    s_sleep 1
    buffer_load_dword v2, v3, s[28:31], s45 offen sc1
    s_add_u32 s82, s82, 1
    s_waitcnt vmcnt(0)
    v_cmp_ne_u32 vcc, s83, v2
    s_nop 1
    s_cmp_eq_u64 vcc, 0
    s_cbranch_scc1 L_ready
    s_cmp_lt_u32 s82, 0x4000
    s_cbranch_scc1 L_spin
L_ready:
    s_lshl_b32 s81, s69, 11
    v_add_u32 v18, s81, v28
    v_xor_b32 v19, 0x800, v18
    v_lshl_add_u32 v17, v0, 4, s57
    v_mfma_f32_32x32x16_bf16 v[64:79], a[192:195], a[128:131], 0
    s_add_u32 m0, s70, 8192
    s_add_u32 s80, s97, 196608
    buffer_load_dwordx4 v13, s[24:27], s80 offen offset:0 lds
    v_mfma_f32_32x32x16_bf16 v[80:95], a[192:195], a[132:135], 0
    buffer_load_dwordx4 v14, s[24:27], s80 offen offset:1024 lds
    v_mfma_f32_32x32x16_bf16 v[128:143], a[224:227], a[128:131], 0
    buffer_load_dwordx4 v15, s[24:27], s80 offen offset:2048 lds
    v_mfma_f32_32x32x16_bf16 v[144:159], a[224:227], a[132:135], 0
    buffer_load_dwordx4 v16, s[24:27], s80 offen offset:3072 lds
    v_cvt_pk_bf16_f32 v192, v192, v193
    v_cvt_pk_bf16_f32 v193, v194, v195
    v_cvt_pk_bf16_f32 v194, v196, v197
    v_mfma_f32_32x32x16_bf16 v[64:79], a[196:199], a[136:139], v[64:79]
    s_add_u32 m0, s70, 32768
    s_lshr_b32 s80, s90, 6
    buffer_load_dwordx4 v17, s[28:31], s80 offen offset:0 sc1 lds
    v_cvt_pk_bf16_f32 v195, v198, v199
    v_cvt_pk_bf16_f32 v196, v200, v201
    v_mfma_f32_32x32x16_bf16 v[80:95], a[196:199], a[140:143], v[80:95]
    buffer_load_dwordx4 v17, s[28:31], s80 offen offset:1024 sc1 lds
    v_cvt_pk_bf16_f32 v197, v202, v203
    v_cvt_pk_bf16_f32 v198, v204, v205
    v_cvt_pk_bf16_f32 v199, v206, v207
    v_mfma_f32_32x32x16_bf16 v[128:143], a[228:231], a[136:139], v[128:143]
    buffer_load_dwordx4 v17, s[28:31], s80 offen offset:2048 sc1 lds
    v_cvt_pk_bf16_f32 v200, v208, v209
    v_cvt_pk_bf16_f32 v201, v210, v211
    v_mfma_f32_32x32x16_bf16 v[144:159], a[228:231], a[140:143], v[144:159]
    buffer_load_dwordx4 v17, s[28:31], s80 offen offset:3072 sc1 lds
    s_waitcnt vmcnt(20)
    ds_read_b64_tr_b16 a[160:161], v26 offset:28672
    ds_read_b64_tr_b16 a[162:163], v26 offset:29184
    v_cvt_pk_bf16_f32 v202, v212, v213
    v_cvt_pk_bf16_f32 v203, v214, v215
    v_cvt_pk_bf16_f32 v204, v216, v217
    v_mfma_f32_32x32x16_bf16 v[64:79], a[200:203], a[144:147], v[64:79]
    ds_read_b64_tr_b16 a[164:165], v27 offset:28672
    ds_read_b64_tr_b16 a[166:167], v27 offset:29184
    v_cvt_pk_bf16_f32 v205, v218, v219
    v_cvt_pk_bf16_f32 v206, v220, v221
    v_mfma_f32_32x32x16_bf16 v[80:95], a[200:203], a[148:151], v[80:95]
    ds_read_b64_tr_b16 a[168:169], v26 offset:30720
    ds_read_b64_tr_b16 a[170:171], v26 offset:31232
    ds_read_b64_tr_b16 a[172:173], v27 offset:30720
    v_cvt_pk_bf16_f32 v207, v222, v223
    v_cvt_pk_bf16_f32 v208, v224, v225
    v_cvt_pk_bf16_f32 v209, v226, v227
    v_mfma_f32_32x32x16_bf16 v[128:143], a[232:235], a[144:147], v[128:143]
    ds_read_b64_tr_b16 a[174:175], v27 offset:31232
    ds_read_b64_tr_b16 a[176:177], v26 offset:16384
    v_cvt_pk_bf16_f32 v210, v228, v229
    v_cvt_pk_bf16_f32 v211, v230, v231
    v_mfma_f32_32x32x16_bf16 v[144:159], a[232:235], a[148:151], v[144:159]
    ds_read_b64_tr_b16 a[178:179], v26 offset:16896
    ds_read_b64_tr_b16 a[180:181], v27 offset:16384
    ds_read_b64_tr_b16 a[182:183], v27 offset:16896
    v_cvt_pk_bf16_f32 v212, v232, v233
    v_cvt_pk_bf16_f32 v213, v234, v235
    v_cvt_pk_bf16_f32 v214, v236, v237
    v_mfma_f32_32x32x16_bf16 v[64:79], a[204:207], a[152:155], v[64:79]
    ds_read_b64_tr_b16 a[184:185], v26 offset:18432
    ds_read_b64_tr_b16 a[186:187], v26 offset:18944
    v_cvt_pk_bf16_f32 v215, v238, v239
    v_cvt_pk_bf16_f32 v216, v240, v241
    v_mfma_f32_32x32x16_bf16 v[80:95], a[204:207], a[156:159], v[80:95]
    ds_read_b64_tr_b16 a[188:189], v27 offset:18432
    ds_read_b64_tr_b16 a[190:191], v27 offset:18944
    v_cvt_pk_bf16_f32 v217, v242, v243
    v_cvt_pk_bf16_f32 v218, v244, v245
    v_cvt_pk_bf16_f32 v219, v246, v247
    v_mfma_f32_32x32x16_bf16 v[128:143], a[236:239], a[152:155], v[128:143]
    v_cvt_pk_bf16_f32 v220, v248, v249
    v_cvt_pk_bf16_f32 v221, v250, v251
    v_mfma_f32_32x32x16_bf16 v[144:159], a[236:239], a[156:159], v[144:159]
    v_cvt_pk_bf16_f32 v222, v252, v253
    v_cvt_pk_bf16_f32 v223, v254, v255
    s_waitcnt lgkmcnt(0)
    v_mfma_f32_32x32x16_bf16 v[64:79], a[208:211], a[160:163], v[64:79]
    s_add_u32 m0, s70, 36864
    s_lshr_b32 s80, s91, 6
    buffer_load_dwordx4 v17, s[28:31], s80 offen offset:0 sc1 lds
    v_mfma_f32_32x32x16_bf16 v[80:95], a[208:211], a[164:167], v[80:95]
    buffer_load_dwordx4 v17, s[28:31], s80 offen offset:1024 sc1 lds
    v_mfma_f32_32x32x16_bf16 v[128:143], a[240:243], a[160:163], v[128:143]
    buffer_load_dwordx4 v17, s[28:31], s80 offen offset:2048 sc1 lds
    v_mfma_f32_32x32x16_bf16 v[144:159], a[240:243], a[164:167], v[144:159]
    buffer_load_dwordx4 v17, s[28:31], s80 offen offset:3072 sc1 lds
    v_mfma_f32_32x32x16_bf16 v[64:79], a[212:215], a[168:171], v[64:79]
    s_add_u32 m0, s70, 0
    s_lshr_b32 s80, s92, 6
    buffer_load_dwordx4 v17, s[28:31], s80 offen offset:0 sc1 lds
    v_mfma_f32_32x32x16_bf16 v[80:95], a[212:215], a[172:175], v[80:95]
    buffer_load_dwordx4 v17, s[28:31], s80 offen offset:1024 sc1 lds
    v_mfma_f32_32x32x16_bf16 v[128:143], a[244:247], a[168:171], v[128:143]
    buffer_load_dwordx4 v17, s[28:31], s80 offen offset:2048 sc1 lds
    v_mfma_f32_32x32x16_bf16 v[144:159], a[244:247], a[172:175], v[144:159]
    buffer_load_dwordx4 v17, s[28:31], s80 offen offset:3072 sc1 lds
    s_waitcnt vmcnt(20)
    ds_read_b64_tr_b16 a[128:129], v26 offset:24576
    ds_read_b64_tr_b16 a[130:131], v26 offset:25088
    v_mfma_f32_32x32x16_bf16 v[64:79], a[216:219], a[176:179], v[64:79]
    ds_read_b64_tr_b16 a[132:133], v27 offset:24576
    ds_read_b64_tr_b16 a[134:135], v27 offset:25088
    v_mfma_f32_32x32x16_bf16 v[80:95], a[216:219], a[180:183], v[80:95]
    ds_read_b64_tr_b16 a[136:137], v26 offset:26624
    ds_read_b64_tr_b16 a[138:139], v26 offset:27136
    ds_read_b64_tr_b16 a[140:141], v27 offset:26624
    v_mfma_f32_32x32x16_bf16 v[128:143], a[248:251], a[176:179], v[128:143]
    ds_read_b64_tr_b16 a[142:143], v27 offset:27136
    ds_read_b64_tr_b16 a[144:145], v26 offset:20480
    v_mfma_f32_32x32x16_bf16 v[144:159], a[248:251], a[180:183], v[144:159]
    ds_read_b64_tr_b16 a[146:147], v26 offset:20992
    ds_read_b64_tr_b16 a[148:149], v27 offset:20480
    ds_read_b64_tr_b16 a[150:151], v27 offset:20992
    v_mfma_f32_32x32x16_bf16 v[64:79], a[220:223], a[184:187], v[64:79]
    ds_read_b64_tr_b16 a[152:153], v26 offset:22528
    ds_read_b64_tr_b16 a[154:155], v26 offset:23040
    v_mfma_f32_32x32x16_bf16 v[80:95], a[220:223], a[188:191], v[80:95]
    ds_read_b64_tr_b16 a[156:157], v27 offset:22528
    ds_read_b64_tr_b16 a[158:159], v27 offset:23040
    v_mfma_f32_32x32x16_bf16 v[128:143], a[252:255], a[184:187], v[128:143]
    v_mfma_f32_32x32x16_bf16 v[144:159], a[252:255], a[188:191], v[144:159]
    s_waitcnt lgkmcnt(0)
    v_mfma_f32_32x32x16_bf16 v[224:239], a[192:195], a[128:131], 0
    s_add_u32 m0, s70, 4096
    s_lshr_b32 s80, s93, 6
    buffer_load_dwordx4 v17, s[28:31], s80 offen offset:0 sc1 lds
    v_mfma_f32_32x32x16_bf16 v[240:255], a[192:195], a[132:135], 0
    buffer_load_dwordx4 v17, s[28:31], s80 offen offset:1024 sc1 lds
    v_mfma_f32_32x32x16_bf16 v[32:47], a[224:227], a[128:131], 0
    buffer_load_dwordx4 v17, s[28:31], s80 offen offset:2048 sc1 lds
    v_mfma_f32_32x32x16_bf16 v[48:63], a[224:227], a[132:135], 0
    buffer_load_dwordx4 v17, s[28:31], s80 offen offset:3072 sc1 lds
    v_cvt_pk_bf16_f32 v64, v64, v65
    v_cvt_pk_bf16_f32 v65, v66, v67
    v_cvt_pk_bf16_f32 v66, v68, v69
    v_mfma_f32_32x32x16_bf16 v[224:239], a[196:199], a[136:139], v[224:239]
    s_add_u32 m0, s70, 28672
    s_lshr_b32 s80, s94, 6
    buffer_load_dwordx4 v17, s[28:31], s80 offen offset:0 sc1 lds
    v_cvt_pk_bf16_f32 v67, v70, v71
    v_cvt_pk_bf16_f32 v68, v72, v73
    v_mfma_f32_32x32x16_bf16 v[240:255], a[196:199], a[140:143], v[240:255]
    buffer_load_dwordx4 v17, s[28:31], s80 offen offset:1024 sc1 lds
    v_cvt_pk_bf16_f32 v69, v74, v75
    v_cvt_pk_bf16_f32 v70, v76, v77
    v_cvt_pk_bf16_f32 v71, v78, v79
    v_mfma_f32_32x32x16_bf16 v[32:47], a[228:231], a[136:139], v[32:47]
    buffer_load_dwordx4 v17, s[28:31], s80 offen offset:2048 sc1 lds
    v_cvt_pk_bf16_f32 v72, v80, v81
    v_cvt_pk_bf16_f32 v73, v82, v83
    v_mfma_f32_32x32x16_bf16 v[48:63], a[228:231], a[140:143], v[48:63]
    buffer_load_dwordx4 v17, s[28:31], s80 offen offset:3072 sc1 lds
    s_waitcnt vmcnt(20)
    ds_read_b64_tr_b16 a[160:161], v26 offset:12288
    ds_read_b64_tr_b16 a[162:163], v26 offset:12800
    v_cvt_pk_bf16_f32 v74, v84, v85
    v_cvt_pk_bf16_f32 v75, v86, v87
    v_cvt_pk_bf16_f32 v76, v88, v89
    v_mfma_f32_32x32x16_bf16 v[224:239], a[200:203], a[144:147], v[224:239]
    ds_read_b64_tr_b16 a[164:165], v27 offset:12288
    ds_read_b64_tr_b16 a[166:167], v27 offset:12800
    v_cvt_pk_bf16_f32 v77, v90, v91
    v_cvt_pk_bf16_f32 v78, v92, v93
    v_mfma_f32_32x32x16_bf16 v[240:255], a[200:203], a[148:151], v[240:255]
    ds_read_b64_tr_b16 a[168:169], v26 offset:14336
    ds_read_b64_tr_b16 a[170:171], v26 offset:14848
    ds_read_b64_tr_b16 a[172:173], v27 offset:14336
    v_cvt_pk_bf16_f32 v79, v94, v95
    v_cvt_pk_bf16_f32 v80, v128, v129
    v_cvt_pk_bf16_f32 v81, v130, v131
    v_mfma_f32_32x32x16_bf16 v[32:47], a[232:235], a[144:147], v[32:47]
    ds_read_b64_tr_b16 a[174:175], v27 offset:14848
    ds_read_b64_tr_b16 a[176:177], v26 offset:8192
    v_cvt_pk_bf16_f32 v82, v132, v133
    v_cvt_pk_bf16_f32 v83, v134, v135
    v_mfma_f32_32x32x16_bf16 v[48:63], a[232:235], a[148:151], v[48:63]
    ds_read_b64_tr_b16 a[178:179], v26 offset:8704
    ds_read_b64_tr_b16 a[180:181], v27 offset:8192
    ds_read_b64_tr_b16 a[182:183], v27 offset:8704
    v_cvt_pk_bf16_f32 v84, v136, v137
    v_cvt_pk_bf16_f32 v85, v138, v139
    v_cvt_pk_bf16_f32 v86, v140, v141
    v_mfma_f32_32x32x16_bf16 v[224:239], a[204:207], a[152:155], v[224:239]
    ds_read_b64_tr_b16 a[184:185], v26 offset:10240
    ds_read_b64_tr_b16 a[186:187], v26 offset:10752
    v_cvt_pk_bf16_f32 v87, v142, v143
    v_cvt_pk_bf16_f32 v88, v144, v145
    v_mfma_f32_32x32x16_bf16 v[240:255], a[204:207], a[156:159], v[240:255]
    ds_read_b64_tr_b16 a[188:189], v27 offset:10240
    ds_read_b64_tr_b16 a[190:191], v27 offset:10752
    v_cvt_pk_bf16_f32 v89, v146, v147
    v_cvt_pk_bf16_f32 v90, v148, v149
    v_cvt_pk_bf16_f32 v91, v150, v151
    v_mfma_f32_32x32x16_bf16 v[32:47], a[236:239], a[152:155], v[32:47]
    v_cvt_pk_bf16_f32 v92, v152, v153
    v_cvt_pk_bf16_f32 v93, v154, v155
    v_mfma_f32_32x32x16_bf16 v[48:63], a[236:239], a[156:159], v[48:63]
    v_cvt_pk_bf16_f32 v94, v156, v157
    v_cvt_pk_bf16_f32 v95, v158, v159
    s_waitcnt lgkmcnt(0)
    v_mfma_f32_32x32x16_bf16 v[224:239], a[208:211], a[160:163], v[224:239]
    s_add_u32 m0, s70, 16384
    s_lshr_b32 s80, s95, 6
    buffer_load_dwordx4 v17, s[28:31], s80 offen offset:0 sc1 lds
    v_mfma_f32_32x32x16_bf16 v[240:255], a[208:211], a[164:167], v[240:255]
    buffer_load_dwordx4 v17, s[28:31], s80 offen offset:1024 sc1 lds
    v_mfma_f32_32x32x16_bf16 v[32:47], a[240:243], a[160:163], v[32:47]
    buffer_load_dwordx4 v17, s[28:31], s80 offen offset:2048 sc1 lds
    v_mfma_f32_32x32x16_bf16 v[48:63], a[240:243], a[164:167], v[48:63]
    buffer_load_dwordx4 v17, s[28:31], s80 offen offset:3072 sc1 lds
    v_mfma_f32_32x32x16_bf16 v[224:239], a[212:215], a[168:171], v[224:239]
    s_add_u32 m0, s70, 24576
    s_lshr_b32 s80, s96, 6
    buffer_load_dwordx4 v17, s[28:31], s80 offen offset:0 sc1 lds
    v_mfma_f32_32x32x16_bf16 v[240:255], a[212:215], a[172:175], v[240:255]
    buffer_load_dwordx4 v17, s[28:31], s80 offen offset:1024 sc1 lds
    v_mfma_f32_32x32x16_bf16 v[32:47], a[244:247], a[168:171], v[32:47]
    buffer_load_dwordx4 v17, s[28:31], s80 offen offset:2048 sc1 lds
    v_mfma_f32_32x32x16_bf16 v[48:63], a[244:247], a[172:175], v[48:63]
    buffer_load_dwordx4 v17, s[28:31], s80 offen offset:3072 sc1 lds
    s_waitcnt vmcnt(20)
    ds_read_b128 a[128:131], v18 offset:32768
    v_mfma_f32_32x32x16_bf16 v[224:239], a[216:219], a[176:179], v[224:239]
    ds_read_b128 a[132:135], v18 offset:33792
    v_mfma_f32_32x32x16_bf16 v[240:255], a[216:219], a[180:183], v[240:255]
    ds_read_b128 a[136:139], v19 offset:32768
    v_mfma_f32_32x32x16_bf16 v[32:47], a[248:251], a[176:179], v[32:47]
    ds_read_b128 a[140:143], v19 offset:33792
    ds_read_b128 a[144:147], v18 offset:36864
    v_mfma_f32_32x32x16_bf16 v[48:63], a[248:251], a[180:183], v[48:63]
    ds_read_b128 a[148:151], v18 offset:37888
    v_mfma_f32_32x32x16_bf16 v[224:239], a[220:223], a[184:187], v[224:239]
    ds_read_b128 a[152:155], v19 offset:36864
    v_mfma_f32_32x32x16_bf16 v[240:255], a[220:223], a[188:191], v[240:255]
    ds_read_b128 a[156:159], v19 offset:37888
    v_mfma_f32_32x32x16_bf16 v[32:47], a[252:255], a[184:187], v[32:47]
    v_mfma_f32_32x32x16_bf16 v[48:63], a[252:255], a[188:191], v[48:63]
    s_waitcnt lgkmcnt(0)
    v_mfma_f32_32x32x16_bf16 v[128:143], a[64:67], a[128:131], 0
    s_add_u32 m0, s70, 20480
    s_lshr_b32 s80, s97, 6
    buffer_load_dwordx4 v17, s[28:31], s80 offen offset:0 sc1 lds
    v_mfma_f32_32x32x16_bf16 a[192:207], a[72:75], a[128:131], 0
    v_mfma_f32_32x32x16_bf16 a[208:223], a[80:83], a[136:139], 0
    buffer_load_dwordx4 v17, s[28:31], s80 offen offset:1024 sc1 lds
    v_mfma_f32_32x32x16_bf16 a[224:239], a[88:91], a[136:139], 0
    v_cvt_pk_bf16_f32 v224, v224, v225
    v_cvt_pk_bf16_f32 v225, v226, v227
    v_cvt_pk_bf16_f32 v226, v228, v229
    v_mfma_f32_32x32x16_bf16 v[128:143], a[68:71], a[132:135], v[128:143]
    v_cvt_pk_bf16_f32 v227, v230, v231
    v_cvt_pk_bf16_f32 v228, v232, v233
    buffer_load_dwordx4 v17, s[28:31], s80 offen offset:2048 sc1 lds
    v_mfma_f32_32x32x16_bf16 a[192:207], a[76:79], a[132:135], a[192:207]
    v_cvt_pk_bf16_f32 v229, v234, v235
    v_cvt_pk_bf16_f32 v230, v236, v237
    v_cvt_pk_bf16_f32 v231, v238, v239
    v_mfma_f32_32x32x16_bf16 a[208:223], a[84:87], a[140:143], a[208:223]
    v_cvt_pk_bf16_f32 v232, v240, v241
    v_cvt_pk_bf16_f32 v233, v242, v243
    buffer_load_dwordx4 v17, s[28:31], s80 offen offset:3072 sc1 lds
    s_waitcnt vmcnt(16)
    ds_read_b128 a[160:163], v18 offset:0
    v_mfma_f32_32x32x16_bf16 a[224:239], a[92:95], a[140:143], a[224:239]
    v_cvt_pk_bf16_f32 v234, v244, v245
    v_cvt_pk_bf16_f32 v235, v246, v247
    v_cvt_pk_bf16_f32 v236, v248, v249
    ds_read_b128 a[164:167], v18 offset:1024
    v_mfma_f32_32x32x16_bf16 v[128:143], a[96:99], a[144:147], v[128:143]
    v_cvt_pk_bf16_f32 v237, v250, v251
    v_cvt_pk_bf16_f32 v238, v252, v253
    ds_read_b128 a[168:171], v19 offset:0
    v_mfma_f32_32x32x16_bf16 a[192:207], a[104:107], a[144:147], a[192:207]
    v_cvt_pk_bf16_f32 v239, v254, v255
    v_cvt_pk_bf16_f32 v240, v32, v33
    v_cvt_pk_bf16_f32 v241, v34, v35
    ds_read_b128 a[172:175], v19 offset:1024
    v_mfma_f32_32x32x16_bf16 a[208:223], a[112:115], a[152:155], a[208:223]
    v_cvt_pk_bf16_f32 v242, v36, v37
    v_cvt_pk_bf16_f32 v243, v38, v39
    ds_read_b128 a[176:179], v18 offset:4096
    v_mfma_f32_32x32x16_bf16 a[224:239], a[120:123], a[152:155], a[224:239]
    v_cvt_pk_bf16_f32 v244, v40, v41
    v_cvt_pk_bf16_f32 v245, v42, v43
    v_cvt_pk_bf16_f32 v246, v44, v45
    ds_read_b128 a[180:183], v18 offset:5120
    v_mfma_f32_32x32x16_bf16 v[128:143], a[100:103], a[148:151], v[128:143]
    v_cvt_pk_bf16_f32 v247, v46, v47
    v_cvt_pk_bf16_f32 v248, v48, v49
    ds_read_b128 a[184:187], v19 offset:4096
    v_mfma_f32_32x32x16_bf16 a[192:207], a[108:111], a[148:151], a[192:207]
    v_cvt_pk_bf16_f32 v249, v50, v51
    v_cvt_pk_bf16_f32 v250, v52, v53
    v_cvt_pk_bf16_f32 v251, v54, v55
    ds_read_b128 a[188:191], v19 offset:5120
    v_mfma_f32_32x32x16_bf16 a[208:223], a[116:119], a[156:159], a[208:223]
    v_cvt_pk_bf16_f32 v252, v56, v57
    v_cvt_pk_bf16_f32 v253, v58, v59
    v_mfma_f32_32x32x16_bf16 a[224:239], a[124:127], a[156:159], a[224:239]
    v_cvt_pk_bf16_f32 v254, v60, v61
    v_cvt_pk_bf16_f32 v255, v62, v63
    s_waitcnt lgkmcnt(0)
    v_mfma_f32_32x32x16_bf16 a[192:207], a[8:11], a[160:163], a[192:207]
    v_mfma_f32_32x32x16_bf16 a[208:223], a[16:19], a[168:171], a[208:223]
    v_mfma_f32_32x32x16_bf16 a[224:239], a[24:27], a[168:171], a[224:239]
    s_waitcnt vmcnt(0)
    ds_read_b128 a[128:131], v18 offset:28672
    ds_read_b128 a[132:135], v18 offset:29696
    v_mfma_f32_32x32x16_bf16 a[192:207], a[12:15], a[164:167], a[192:207]
    ds_read_b128 a[136:139], v19 offset:28672
    ds_read_b128 a[140:143], v19 offset:29696
    v_mfma_f32_32x32x16_bf16 a[208:223], a[20:23], a[172:175], a[208:223]
    ds_read_b128 a[144:147], v18 offset:16384
    ds_read_b128 a[148:151], v18 offset:17408
    v_mfma_f32_32x32x16_bf16 a[224:239], a[28:31], a[172:175], a[224:239]
    ds_read_b128 a[152:155], v19 offset:16384
    ds_read_b128 a[156:159], v19 offset:17408
    v_mfma_f32_32x32x16_bf16 a[192:207], v[104:107], a[176:179], a[192:207]
    ds_read_b128 a[32:35], v18 offset:24576
    ds_read_b128 a[36:39], v18 offset:25600
    v_mfma_f32_32x32x16_bf16 a[208:223], v[112:115], a[184:187], a[208:223]
    ds_read_b128 a[40:43], v19 offset:24576
    ds_read_b128 a[44:47], v19 offset:25600
    v_mfma_f32_32x32x16_bf16 a[224:239], v[120:123], a[184:187], a[224:239]
    ds_read_b128 a[48:51], v18 offset:20480
    ds_read_b128 a[52:55], v18 offset:21504
    v_mfma_f32_32x32x16_bf16 a[192:207], v[108:111], a[180:183], a[192:207]
    ds_read_b128 a[56:59], v19 offset:20480
    ds_read_b128 a[60:63], v19 offset:21504
    v_mfma_f32_32x32x16_bf16 a[208:223], v[116:119], a[188:191], a[208:223]
    v_mfma_f32_32x32x16_bf16 a[224:239], v[124:127], a[188:191], a[224:239]
    s_waitcnt lgkmcnt(0)
    v_mfma_f32_32x32x16_bf16 a[192:207], v[168:171], a[128:131], a[192:207]
    v_and_b32 v4, 31, v0
    v_mfma_f32_32x32x16_bf16 a[192:207], v[172:175], a[132:135], a[192:207]
    v_lshrrev_b32 v5, 5, v0
    v_mfma_f32_32x32x16_bf16 a[192:207], v[200:203], a[144:147], a[192:207]
    v_lshlrev_b32 v4, 12, v4
    v_mfma_f32_32x32x16_bf16 a[192:207], v[204:207], a[148:151], a[192:207]
    v_lshl_add_u32 v4, v5, 5, v4
    v_mfma_f32_32x32x16_bf16 a[192:207], v[72:75], a[32:35], a[192:207]
    v_add_u32 v1, s41, v28
    v_mfma_f32_32x32x16_bf16 a[192:207], v[76:79], a[36:39], a[192:207]
    v_add_u32 v2, s42, v28
    v_mfma_f32_32x32x16_bf16 a[192:207], v[232:235], a[48:51], a[192:207]
    v_add_u32 v3, s43, v28
    v_mfma_f32_32x32x16_bf16 a[192:207], v[236:239], a[52:55], a[192:207]
    v_mfma_f32_32x32x16_bf16 a[208:223], v[176:179], a[136:139], a[208:223]
    v_mfma_f32_32x32x16_bf16 a[208:223], v[180:183], a[140:143], a[208:223]
    v_mfma_f32_32x32x16_bf16 a[208:223], v[208:211], a[152:155], a[208:223]
    v_mfma_f32_32x32x16_bf16 a[208:223], v[212:215], a[156:159], a[208:223]
    v_mfma_f32_32x32x16_bf16 a[208:223], v[80:83], a[40:43], a[208:223]
    v_mfma_f32_32x32x16_bf16 a[208:223], v[84:87], a[44:47], a[208:223]
    v_mfma_f32_32x32x16_bf16 a[208:223], v[240:243], a[56:59], a[208:223]
    v_mfma_f32_32x32x16_bf16 a[208:223], v[244:247], a[60:63], a[208:223]
    v_mfma_f32_32x32x16_bf16 a[224:239], v[184:187], a[136:139], a[224:239]
    v_mfma_f32_32x32x16_bf16 a[224:239], v[188:191], a[140:143], a[224:239]
    v_mfma_f32_32x32x16_bf16 a[224:239], v[216:219], a[152:155], a[224:239]
    s_nop 0
    ds_write_b128 v28, a[192:195] offset:12288
    v_mfma_f32_32x32x16_bf16 a[224:239], v[220:223], a[156:159], a[224:239]
    ds_write_b128 v28, a[196:199] offset:13312
    ds_write_b128 v28, a[200:203] offset:14336
    v_mfma_f32_32x32x16_bf16 a[224:239], v[88:91], a[40:43], a[224:239]
    ds_write_b128 v28, a[204:207] offset:15360
    v_mfma_f32_32x32x16_bf16 a[224:239], v[92:95], a[44:47], a[224:239]
    v_mfma_f32_32x32x16_bf16 a[224:239], v[248:251], a[56:59], a[224:239]
    ds_write_b128 v28, a[208:211] offset:8192
    v_mfma_f32_32x32x16_bf16 a[224:239], v[252:255], a[60:63], a[224:239]
    ds_write_b128 v28, a[212:215] offset:9216
    ds_write_b128 v28, a[216:219] offset:10240
    v_mfma_f32_32x32x16_bf16 v[128:143], a[0:3], a[160:163], v[128:143]
    ds_write_b128 v28, a[220:223] offset:11264
    s_nop 3
    v_mfma_f32_32x32x16_bf16 v[128:143], a[4:7], a[164:167], v[128:143]
    s_nop 2
    ds_write_b128 v28, a[224:227] offset:32768
    ds_write_b128 v28, a[228:231] offset:33792
    ds_write_b128 v28, a[232:235] offset:34816
    ds_write_b128 v28, a[236:239] offset:35840
    v_mfma_f32_32x32x16_bf16 v[128:143], v[96:99], a[176:179], v[128:143]
    v_mfma_f32_32x32x16_bf16 v[128:143], v[100:103], a[180:183], v[128:143]
    v_mfma_f32_32x32x16_bf16 v[128:143], v[160:163], a[128:131], v[128:143]
    s_waitcnt lgkmcnt(0)
    s_barrier
    ds_read_b128 v[32:35], v1 offset:12288
    ds_read_b128 v[36:39], v1 offset:13312
    ds_read_b128 v[40:43], v1 offset:14336
    ds_read_b128 v[44:47], v1 offset:15360
    ds_read_b128 v[48:51], v2 offset:8192
    ds_read_b128 v[52:55], v2 offset:9216
    ds_read_b128 v[56:59], v2 offset:10240
    ds_read_b128 v[60:63], v2 offset:11264
    ds_read_b128 v[144:147], v3 offset:32768
    ds_read_b128 v[148:151], v3 offset:33792
    ds_read_b128 v[152:155], v3 offset:34816
    ds_read_b128 v[156:159], v3 offset:35840
    v_mfma_f32_32x32x16_bf16 v[128:143], v[164:167], a[132:135], v[128:143]
    v_mfma_f32_32x32x16_bf16 v[128:143], v[192:195], a[144:147], v[128:143]
    v_mfma_f32_32x32x16_bf16 v[128:143], v[196:199], a[148:151], v[128:143]
    v_mfma_f32_32x32x16_bf16 v[128:143], v[64:67], a[32:35], v[128:143]
    v_mfma_f32_32x32x16_bf16 v[128:143], v[68:71], a[36:39], v[128:143]
    v_mfma_f32_32x32x16_bf16 v[128:143], v[224:227], a[48:51], v[128:143]
    v_mfma_f32_32x32x16_bf16 v[128:143], v[228:231], a[52:55], v[128:143]
    s_waitcnt lgkmcnt(0)
    v_pk_add_f32 v[32:33], v[32:33], v[48:49]
    v_pk_add_f32 v[34:35], v[34:35], v[50:51]
    v_pk_add_f32 v[36:37], v[36:37], v[52:53]
    v_pk_add_f32 v[38:39], v[38:39], v[54:55]
    v_pk_add_f32 v[40:41], v[40:41], v[56:57]
    v_pk_add_f32 v[42:43], v[42:43], v[58:59]
    v_pk_add_f32 v[44:45], v[44:45], v[60:61]
    v_pk_add_f32 v[46:47], v[46:47], v[62:63]
    v_pk_add_f32 v[32:33], v[32:33], v[144:145]
    v_pk_add_f32 v[34:35], v[34:35], v[146:147]
    v_pk_add_f32 v[36:37], v[36:37], v[148:149]
    v_pk_add_f32 v[38:39], v[38:39], v[150:151]
    v_pk_add_f32 v[40:41], v[40:41], v[152:153]
    v_pk_add_f32 v[42:43], v[42:43], v[154:155]
    v_pk_add_f32 v[44:45], v[44:45], v[156:157]
    v_pk_add_f32 v[46:47], v[46:47], v[158:159]
    v_pk_add_f32 v[128:129], v[128:129], v[32:33]
    v_pk_add_f32 v[130:131], v[130:131], v[34:35]
    v_pk_add_f32 v[132:133], v[132:133], v[36:37]
    v_pk_add_f32 v[134:135], v[134:135], v[38:39]
    v_pk_add_f32 v[136:137], v[136:137], v[40:41]
    v_pk_add_f32 v[138:139], v[138:139], v[42:43]
    v_pk_add_f32 v[140:141], v[140:141], v[44:45]
    v_pk_add_f32 v[142:143], v[142:143], v[46:47]
    v_cvt_pk_bf16_f32 v128, v128, v129
    v_cvt_pk_bf16_f32 v129, v130, v131
    v_cvt_pk_bf16_f32 v130, v132, v133
    v_cvt_pk_bf16_f32 v131, v134, v135
    v_cvt_pk_bf16_f32 v132, v136, v137
    v_cvt_pk_bf16_f32 v133, v138, v139
    v_cvt_pk_bf16_f32 v134, v140, v141
    v_cvt_pk_bf16_f32 v135, v142, v143
    buffer_store_dwordx4 v[128:131], v4, s[32:35], s47 offen offset:0
    buffer_store_dwordx4 v[132:135], v4, s[32:35], s47 offen offset:16
L_end:
    s_endpgm
.section .rodata,"a"
.p2align 6
.amdhsa_kernel concat_heads__gqa_block_cached__gqa_block_cached__near_ridge_kernel
  .amdhsa_next_free_vgpr 512
  .amdhsa_next_free_sgpr 102
  .amdhsa_accum_offset 256
  .amdhsa_group_segment_fixed_size 0
  .amdhsa_kernarg_size 104
  .amdhsa_user_sgpr_count 2
  .amdhsa_user_sgpr_kernarg_segment_ptr 1
  .amdhsa_system_sgpr_workgroup_id_x 1
.end_amdhsa_kernel
```
